```python
import torch

def _softmax(x, axis=-1):
    return torch.softmax(x, dim=axis)
def _gelu(x):
    return torch.nn.functional.gelu(x, approximate="tanh")
def _silu(x):
    return torch.nn.functional.silu(x)
def _sigmoid(x):
    return torch.sigmoid(x)
def _layernorm(x, axis=-1, eps=1e-5):
    m = x.mean(dim=axis, keepdim=True)
    v = x.var(dim=axis, keepdim=True, unbiased=False)
    return (x - m) / torch.sqrt(v + eps)
def _scatter_add(tgt, idx, src, axis=0):
    return tgt.clone().index_add_(axis, idx, src)
def _segment_sum(src, seg, n):
    out = torch.zeros((n,) + src.shape[1:], dtype=src.dtype)
    return out.index_add_(0, seg, src)
def _pad(x, pw):
    flat = tuple(v for pair in reversed(pw) for v in pair)
    return torch.nn.functional.pad(x, flat)

kernel_name = 'concat_heads__linear_kernel_hedgehog__softmax_full_mha__prompt'

def setup_inputs():

    _w = (lambda a: (lambda t: t.to(torch.bfloat16) if t.is_floating_point() else t)(torch.as_tensor(a)))
    def _A_setup():
        B, S, D, H = 1, 2048, 512, 32
        Dh = D // H
        return {
            "x": _w((lambda *s: torch.randn(*s, dtype=torch.bfloat16) * 0.8)(B, S, D)),
            "wqkv": _w((lambda *s: torch.randn(*s, dtype=torch.bfloat16) * 1.6)(D, 3 * D)),
            "w_phi": _w((lambda *s: torch.randn(*s, dtype=torch.bfloat16) * 1.6)(H, Dh, Dh) * (Dh ** -0.5)),
            "wo": _w((lambda *s: torch.randn(*s, dtype=torch.bfloat16) * 0.1)(D, D)),
        }
    _A_in = _A_setup()

    def _B_setup():
        B, S, D = 1, 2048, 512
        return {
            "x": _w((lambda *s: torch.randn(*s, dtype=torch.bfloat16) * 0.4)(B, S, D)),
            "wqkv": _w((lambda *s: torch.randn(*s, dtype=torch.bfloat16) * 0.4)(D, 3 * D)),
            "wo": _w((lambda *s: torch.randn(*s, dtype=torch.bfloat16) * 0.05)(D, D)),
        }
    _B_in = _B_setup()

    return {
        "A_x": _A_in["x"],
        "A_wqkv": _A_in["wqkv"],
        "A_w_phi": _A_in["w_phi"],
        "A_wo": _A_in["wo"],
        "B_x": _B_in["x"],
        "B_wqkv": _B_in["wqkv"],
        "B_wo": _B_in["wo"],
    }

def reference(A_x, A_wqkv, A_w_phi, A_wo, B_x, B_wqkv, B_wo):
    def _A_ref(x, wqkv, w_phi, wo):
        B, S, D = x.shape
        H = 32; Dh = D // H
        qkv = (lambda x, *d: x.permute(*d))((x @ wqkv).reshape(B, S, 3, H, Dh), 2, 0, 3, 1, 4)
        q, k, v = qkv[0], qkv[1], qkv[2]
        pq = torch.einsum("bhsd,hdf->bhsf", q, w_phi)
        pk = torch.einsum("bhsd,hdf->bhsf", k, w_phi)
        phi_q = torch.concatenate([_softmax(pq, axis=-1), _softmax(-pq, axis=-1)], axis=-1)
        phi_k = torch.concatenate([_softmax(pk, axis=-1), _softmax(-pk, axis=-1)], axis=-1)
        kv = torch.einsum("bhsf,bhsd->bhfd", phi_k, v)
        z  = torch.einsum("bhsf->bhf", phi_k)
        num = torch.einsum("bhqf,bhfd->bhqd", phi_q, kv)
        den = torch.einsum("bhqf,bhf->bhq", phi_q, z)[..., None] + 1e-6
        o = num / den
        return (lambda x, *d: x.permute(*d))(o, 0, 2, 1, 3).reshape(B, S, D) @ wo

    def _B_ref(x, wqkv, wo):
        B, S, D = x.shape
        H = 32; Dh = D // H
        qkv = (lambda x, *d: x.permute(*d))((x @ wqkv).reshape(B, S, 3, H, Dh), 2, 0, 3, 1, 4)
        q, k, v = qkv[0], qkv[1], qkv[2]
        scale = Dh ** -0.5
        scores = torch.einsum("bhqd,bhkd->bhqk", q, k) * scale
        p = _softmax(scores, axis=-1)
        o = torch.einsum("bhqk,bhkd->bhqd", p, v)
        return (lambda x, *d: x.permute(*d))(o, 0, 2, 1, 3).reshape(B, S, D) @ wo

    a = _A_ref(A_x, A_wqkv, A_w_phi, A_wo)
    b = _B_ref(B_x, B_wqkv, B_wo)
    return torch.concatenate([a, b], axis=-1)
```

```asm
; @launch grid=(256,1,1) block=(512,1,1) lds=163840
.amdgcn_target "amdgcn-amd-amdhsa--gfx950"
.text
.globl concat_heads__linear_kernel_hedgehog__softmax_full_mha__prompt_kernel
.p2align 8
.type concat_heads__linear_kernel_hedgehog__softmax_full_mha__prompt_kernel,@function
concat_heads__linear_kernel_hedgehog__softmax_full_mha__prompt_kernel:
  s_cmp_ge_u32 s2, 256
  s_cbranch_scc1 k_end
  s_load_dwordx4 s[4:7], s[0:1], 0
  s_load_dwordx4 s[40:43], s[0:1], 32
  s_load_dwordx4 s[44:47], s[0:1], 16
  s_load_dwordx4 s[56:59], s[0:1], 48
  s_load_dwordx4 s[36:39], s[0:1], 64
  s_getpc_b64 s[8:9]
pc_here:
  s_sub_u32 s8, s8, pc_here-concat_heads__linear_kernel_hedgehog__softmax_full_mha__prompt_kernel
  s_subb_u32 s9, s9, 0
  s_and_b32 s3, s2, 0xf8
  v_add_u32 v6, s3, v0
  v_lshlrev_b32 v6, 7, v6
  v_min_u32 v6, k_end-concat_heads__linear_kernel_hedgehog__softmax_full_mha__prompt_kernel, v6
  v_cmp_gt_u32 vcc, 8, v0
  s_nop 1
  s_and_saveexec_b64 s[34:35], vcc
  s_cbranch_execz no_pf
  global_load_dword v127, v6, s[8:9]
no_pf:
  s_mov_b64 exec, s[34:35]
  v_lshrrev_b32 v1, 6, v0
  v_and_b32 v0, 63, v0
  v_readfirstlane_b32 s24, v1
  s_and_b32 s3, s2, 7
  s_lshr_b32 s30, s2, 3
  s_and_b32 s25, s30, 1
  s_lshr_b32 s31, s30, 1
  s_and_b32 s26, s3, 3
  s_lshl_b32 s26, s26, 2
  s_and_b32 s10, s31, 3
  s_add_u32 s26, s26, s10
  s_and_b32 s27, s3, 4
  s_lshr_b32 s10, s31, 2
  s_add_u32 s27, s27, s10
  s_lshl_b32 s10, s25, 2
  s_xor_b32 s27, s27, s10
  s_cmp_ge_u32 s24, 4
  s_cbranch_scc0 comp_setup
  v_lshrrev_b32 v12, 3, v0
  v_lshrrev_b32 v6, 4, v0
  v_and_b32 v7, 7, v0
  v_xor_b32 v13, v7, v6
  v_lshlrev_b32 v13, 4, v13
  v_lshl_add_u32 v8, v12, 10, v13
  v_xor_b32 v9, 64, v8
  v_mul_u32_u24 v14, 3072, v12
  v_and_b32 v13, 1, v6
  v_xor_b32 v15, v7, v13
  v_lshl_add_u32 v10, v15, 4, v14
  v_xor_b32 v11, 64, v10
  v_lshlrev_b32 v13, 1, v13
  v_xor_b32 v15, v7, v13
  v_lshl_add_u32 v16, v15, 4, v14
  v_xor_b32 v17, 64, v16
  s_sub_u32 s31, s24, 4
  s_mov_b32 s14, 0x200000
  s_mov_b32 s15, 0x00020000
  s_mov_b32 s18, 0x180000
  s_mov_b32 s19, 0x00020000
  s_lshl_b32 s92, s26, 17
  s_lshl_b32 s10, s31, 15
  s_add_u32 s92, s92, s10
  s_mul_i32 s93, s31, 24576
  s_lshl_b32 s10, s27, 7
  s_add_u32 s93, s93, s10
  s_lshl_b32 s94, s31, 12
  s_lshr_b32 s10, s31, 1
  s_mul_i32 s95, s10, 6144
  s_and_b32 s10, s31, 1
  s_lshl_b32 s3, s10, 10
  s_add_u32 s95, s95, s3
  s_lshl_b32 s10, s10, 6
  v_xor_b32 v10, s10, v10
  v_xor_b32 v16, s10, v16
  s_add_u32 s95, s95, 65536
  s_add_u32 s96, s26, s27
  s_and_b32 s96, s96, 1
  s_lshl_b32 s96, s96, 2
  s_lshl_b32 s97, s25, 1
  s_add_u32 s96, s96, s97
  s_and_b32 s97, s2, 1
  s_add_u32 s96, s96, s97
  s_and_b32 s97, s96, 7
  s_mul_i32 s9, s97, 196608
  s_add_u32 s9, s9, s93
  s_lshl_b32 s97, s97, 7
  s_add_u32 s8, s97, s92
  s_waitcnt lgkmcnt(0)
  s_cmp_eq_u32 s25, 0
  s_cselect_b32 s12, s4, s40
  s_cselect_b32 s13, s5, s41
  s_cselect_b32 s16, s6, s42
  s_cselect_b32 s17, s7, s43
  s_add_u32 m0, s95, 0
  s_add_u32 s30, s9, 0
  buffer_load_dwordx4 v10, s[16:19], s30 offen lds
  s_add_u32 m0, s94, 0
  s_add_u32 s30, s8, 0
  buffer_load_dwordx4 v8, s[12:15], s30 offen lds
  s_add_u32 m0, s95, 2048
  s_add_u32 s30, s9, 1024
  buffer_load_dwordx4 v10, s[16:19], s30 offen lds
  s_add_u32 m0, s94, 1024
  s_add_u32 s30, s8, 8192
  buffer_load_dwordx4 v9, s[12:15], s30 offen lds
  s_add_u32 m0, s95, 4096
  s_add_u32 s30, s9, 2048
  buffer_load_dwordx4 v16, s[16:19], s30 offen lds
  s_add_u32 m0, s94, 2048
  s_add_u32 s30, s8, 16384
  buffer_load_dwordx4 v8, s[12:15], s30 offen lds
  s_add_u32 m0, s94, 3072
  s_add_u32 s30, s8, 24576
  buffer_load_dwordx4 v9, s[12:15], s30 offen lds
  s_add_u32 m0, s95, 12288
  s_add_u32 s30, s9, 98304
  buffer_load_dwordx4 v10, s[16:19], s30 offen lds
  s_add_u32 m0, s95, 14336
  s_add_u32 s30, s9, 99328
  buffer_load_dwordx4 v10, s[16:19], s30 offen lds
  s_add_u32 m0, s95, 16384
  s_add_u32 s30, s9, 100352
  buffer_load_dwordx4 v16, s[16:19], s30 offen lds
  s_add_u32 s97, s96, 1
  s_and_b32 s97, s97, 7
  s_mul_i32 s9, s97, 196608
  s_add_u32 s9, s9, s93
  s_lshl_b32 s97, s97, 7
  s_add_u32 s8, s97, s92
  s_add_u32 m0, s95, 24576
  s_add_u32 s30, s9, 0
  buffer_load_dwordx4 v10, s[16:19], s30 offen lds
  s_add_u32 m0, s94, 16384
  s_add_u32 s30, s8, 0
  buffer_load_dwordx4 v8, s[12:15], s30 offen lds
  s_add_u32 m0, s95, 26624
  s_add_u32 s30, s9, 1024
  buffer_load_dwordx4 v10, s[16:19], s30 offen lds
  s_add_u32 m0, s94, 17408
  s_add_u32 s30, s8, 8192
  buffer_load_dwordx4 v9, s[12:15], s30 offen lds
  s_and_b32 s3, s2, 7
  s_lshr_b32 s30, s2, 3
  s_and_b32 s10, s30, 7
  s_lshl_b32 s101, s3, 3
  s_add_u32 s101, s101, s10
  s_lshr_b32 s11, s30, 3
  s_lshl_b32 s28, s3, 2
  s_and_b32 s10, s30, 3
  s_add_u32 s28, s28, s10
  s_lshr_b32 s29, s30, 2
  v_lshlrev_b32 v1, 4, v0
  s_bitcmp0_b32 s2, 2
  s_cselect_b32 s6, s6, s42
  s_cselect_b32 s7, s7, s43
  s_cselect_b32 s4, 0, 2
  s_and_b32 s3, s2, 1
  s_add_u32 s4, s4, s3
  s_lshr_b32 s3, s2, 3
  s_lshl_b32 s3, s3, 2
  s_add_u32 s3, s3, s31
  s_lshr_b32 s5, s3, 6
  s_lshl_b32 s5, s5, 2
  s_add_u32 s4, s4, s5
  s_and_b32 s3, s3, 63
  s_mul_i32 s3, s3, 3072
  s_add_u32 s3, s3, 384
  s_add_u32 s6, s6, s3
  s_addc_u32 s7, s7, 0
  s_add_u32 s10, s4, 1
  s_and_b32 s10, s10, 7
  s_mul_i32 s3, s10, 196608
  s_load_dword s60, s[6:7], s3 offset:0
  s_load_dword s61, s[6:7], s3 offset:64
  s_load_dword s62, s[6:7], s3 offset:1024
  s_load_dword s63, s[6:7], s3 offset:1088
  s_load_dword s64, s[6:7], s3 offset:2048
  s_load_dword s65, s[6:7], s3 offset:2112
  s_waitcnt vmcnt(7)
  s_barrier
  s_add_u32 m0, s95, 28672
  s_add_u32 s30, s9, 2048
  buffer_load_dwordx4 v16, s[16:19], s30 offen lds
  s_add_u32 m0, s94, 18432
  s_add_u32 s30, s8, 16384
  buffer_load_dwordx4 v8, s[12:15], s30 offen lds
  s_add_u32 m0, s94, 19456
  s_add_u32 s30, s8, 24576
  buffer_load_dwordx4 v9, s[12:15], s30 offen lds
  s_add_u32 m0, s95, 36864
  s_add_u32 s30, s9, 98304
  buffer_load_dwordx4 v10, s[16:19], s30 offen lds
  s_add_u32 m0, s95, 38912
  s_add_u32 s30, s9, 99328
  buffer_load_dwordx4 v10, s[16:19], s30 offen lds
  s_add_u32 m0, s95, 40960
  s_add_u32 s30, s9, 100352
  buffer_load_dwordx4 v16, s[16:19], s30 offen lds
  s_add_u32 s10, s4, 2
  s_and_b32 s10, s10, 7
  s_mul_i32 s3, s10, 196608
  s_load_dword s66, s[6:7], s3 offset:0
  s_load_dword s67, s[6:7], s3 offset:64
  s_load_dword s68, s[6:7], s3 offset:1024
  s_load_dword s69, s[6:7], s3 offset:1088
  s_load_dword s70, s[6:7], s3 offset:2048
  s_load_dword s71, s[6:7], s3 offset:2112
  s_waitcnt vmcnt(10)
  s_barrier
  s_add_u32 s97, s96, 2
  s_and_b32 s97, s97, 7
  s_mul_i32 s9, s97, 196608
  s_add_u32 s9, s9, s93
  s_lshl_b32 s97, s97, 7
  s_add_u32 s8, s97, s92
  s_add_u32 m0, s95, 49152
  s_add_u32 s30, s9, 0
  buffer_load_dwordx4 v10, s[16:19], s30 offen lds
  s_add_u32 m0, s94, 32768
  s_add_u32 s30, s8, 0
  buffer_load_dwordx4 v8, s[12:15], s30 offen lds
  s_add_u32 m0, s95, 51200
  s_add_u32 s30, s9, 1024
  buffer_load_dwordx4 v10, s[16:19], s30 offen lds
  s_add_u32 m0, s94, 33792
  s_add_u32 s30, s8, 8192
  buffer_load_dwordx4 v9, s[12:15], s30 offen lds
  s_add_u32 m0, s95, 53248
  s_add_u32 s30, s9, 2048
  buffer_load_dwordx4 v16, s[16:19], s30 offen lds
  s_add_u32 m0, s94, 34816
  s_add_u32 s30, s8, 16384
  buffer_load_dwordx4 v8, s[12:15], s30 offen lds
  s_add_u32 m0, s94, 35840
  s_add_u32 s30, s8, 24576
  buffer_load_dwordx4 v9, s[12:15], s30 offen lds
  s_add_u32 s10, s4, 3
  s_and_b32 s10, s10, 7
  s_mul_i32 s3, s10, 196608
  s_load_dword s72, s[6:7], s3 offset:0
  s_load_dword s73, s[6:7], s3 offset:64
  s_load_dword s74, s[6:7], s3 offset:1024
  s_load_dword s75, s[6:7], s3 offset:1088
  s_load_dword s76, s[6:7], s3 offset:2048
  s_load_dword s77, s[6:7], s3 offset:2112
  s_waitcnt vmcnt(10)
  s_barrier
  s_add_u32 m0, s95, 61440
  s_add_u32 s30, s9, 98304
  buffer_load_dwordx4 v10, s[16:19], s30 offen lds
  s_add_u32 m0, s95, 63488
  s_add_u32 s30, s9, 99328
  buffer_load_dwordx4 v10, s[16:19], s30 offen lds
  s_add_u32 m0, s95, 65536
  s_add_u32 s30, s9, 100352
  buffer_load_dwordx4 v16, s[16:19], s30 offen lds
  s_waitcnt vmcnt(10)
  s_barrier
  s_add_u32 s97, s96, 3
  s_and_b32 s97, s97, 7
  s_mul_i32 s9, s97, 196608
  s_add_u32 s9, s9, s93
  s_lshl_b32 s97, s97, 7
  s_add_u32 s8, s97, s92
  s_add_u32 m0, s95, 73728
  s_add_u32 s30, s9, 0
  buffer_load_dwordx4 v10, s[16:19], s30 offen lds
  s_add_u32 m0, s94, 49152
  s_add_u32 s30, s8, 0
  buffer_load_dwordx4 v8, s[12:15], s30 offen lds
  s_add_u32 m0, s95, 75776
  s_add_u32 s30, s9, 1024
  buffer_load_dwordx4 v10, s[16:19], s30 offen lds
  s_add_u32 m0, s94, 50176
  s_add_u32 s30, s8, 8192
  buffer_load_dwordx4 v9, s[12:15], s30 offen lds
  s_add_u32 m0, s95, 77824
  s_add_u32 s30, s9, 2048
  buffer_load_dwordx4 v16, s[16:19], s30 offen lds
  s_add_u32 m0, s94, 51200
  s_add_u32 s30, s8, 16384
  buffer_load_dwordx4 v8, s[12:15], s30 offen lds
  s_add_u32 m0, s94, 52224
  s_add_u32 s30, s8, 24576
  buffer_load_dwordx4 v9, s[12:15], s30 offen lds
  s_waitcnt vmcnt(10)
  s_barrier
  s_add_u32 m0, s95, 86016
  s_add_u32 s30, s9, 98304
  buffer_load_dwordx4 v10, s[16:19], s30 offen lds
  s_add_u32 m0, s95, 88064
  s_add_u32 s30, s9, 99328
  buffer_load_dwordx4 v10, s[16:19], s30 offen lds
  s_add_u32 m0, s95, 90112
  s_add_u32 s30, s9, 100352
  buffer_load_dwordx4 v16, s[16:19], s30 offen lds
  s_waitcnt vmcnt(10)
  s_barrier
  s_add_u32 s97, s96, 4
  s_and_b32 s97, s97, 7
  s_mul_i32 s9, s97, 196608
  s_add_u32 s9, s9, s93
  s_lshl_b32 s97, s97, 7
  s_add_u32 s8, s97, s92
  s_add_u32 m0, s95, 0
  s_add_u32 s30, s9, 0
  buffer_load_dwordx4 v10, s[16:19], s30 offen lds
  s_add_u32 m0, s94, 0
  s_add_u32 s30, s8, 0
  buffer_load_dwordx4 v8, s[12:15], s30 offen lds
  s_add_u32 m0, s95, 2048
  s_add_u32 s30, s9, 1024
  buffer_load_dwordx4 v10, s[16:19], s30 offen lds
  s_add_u32 m0, s94, 1024
  s_add_u32 s30, s8, 8192
  buffer_load_dwordx4 v9, s[12:15], s30 offen lds
  s_add_u32 m0, s95, 4096
  s_add_u32 s30, s9, 2048
  buffer_load_dwordx4 v16, s[16:19], s30 offen lds
  s_add_u32 m0, s94, 2048
  s_add_u32 s30, s8, 16384
  buffer_load_dwordx4 v8, s[12:15], s30 offen lds
  s_add_u32 m0, s94, 3072
  s_add_u32 s30, s8, 24576
  buffer_load_dwordx4 v9, s[12:15], s30 offen lds
  s_waitcnt vmcnt(10)
  s_barrier
  s_add_u32 m0, s95, 12288
  s_add_u32 s30, s9, 98304
  buffer_load_dwordx4 v10, s[16:19], s30 offen lds
  s_add_u32 m0, s95, 14336
  s_add_u32 s30, s9, 99328
  buffer_load_dwordx4 v10, s[16:19], s30 offen lds
  s_add_u32 m0, s95, 16384
  s_add_u32 s30, s9, 100352
  buffer_load_dwordx4 v16, s[16:19], s30 offen lds
  s_waitcnt vmcnt(10)
  s_barrier
  s_add_u32 s97, s96, 5
  s_and_b32 s97, s97, 7
  s_mul_i32 s9, s97, 196608
  s_add_u32 s9, s9, s93
  s_lshl_b32 s97, s97, 7
  s_add_u32 s8, s97, s92
  s_add_u32 m0, s95, 24576
  s_add_u32 s30, s9, 0
  buffer_load_dwordx4 v10, s[16:19], s30 offen lds
  s_add_u32 m0, s94, 16384
  s_add_u32 s30, s8, 0
  buffer_load_dwordx4 v8, s[12:15], s30 offen lds
  s_add_u32 m0, s95, 26624
  s_add_u32 s30, s9, 1024
  buffer_load_dwordx4 v10, s[16:19], s30 offen lds
  s_add_u32 m0, s94, 17408
  s_add_u32 s30, s8, 8192
  buffer_load_dwordx4 v9, s[12:15], s30 offen lds
  s_add_u32 m0, s95, 28672
  s_add_u32 s30, s9, 2048
  buffer_load_dwordx4 v16, s[16:19], s30 offen lds
  s_add_u32 m0, s94, 18432
  s_add_u32 s30, s8, 16384
  buffer_load_dwordx4 v8, s[12:15], s30 offen lds
  s_add_u32 m0, s94, 19456
  s_add_u32 s30, s8, 24576
  buffer_load_dwordx4 v9, s[12:15], s30 offen lds
  s_waitcnt vmcnt(10)
  s_barrier
  s_add_u32 m0, s95, 36864
  s_add_u32 s30, s9, 98304
  buffer_load_dwordx4 v10, s[16:19], s30 offen lds
  s_add_u32 m0, s95, 38912
  s_add_u32 s30, s9, 99328
  buffer_load_dwordx4 v10, s[16:19], s30 offen lds
  s_add_u32 m0, s95, 40960
  s_add_u32 s30, s9, 100352
  buffer_load_dwordx4 v16, s[16:19], s30 offen lds
  s_waitcnt vmcnt(10)
  s_barrier
  s_add_u32 s97, s96, 6
  s_and_b32 s97, s97, 7
  s_mul_i32 s9, s97, 196608
  s_add_u32 s9, s9, s93
  s_lshl_b32 s97, s97, 7
  s_add_u32 s8, s97, s92
  s_add_u32 m0, s95, 49152
  s_add_u32 s30, s9, 0
  buffer_load_dwordx4 v10, s[16:19], s30 offen lds
  s_add_u32 m0, s94, 32768
  s_add_u32 s30, s8, 0
  buffer_load_dwordx4 v8, s[12:15], s30 offen lds
  s_add_u32 m0, s95, 51200
  s_add_u32 s30, s9, 1024
  buffer_load_dwordx4 v10, s[16:19], s30 offen lds
  s_add_u32 m0, s94, 33792
  s_add_u32 s30, s8, 8192
  buffer_load_dwordx4 v9, s[12:15], s30 offen lds
  s_add_u32 m0, s95, 53248
  s_add_u32 s30, s9, 2048
  buffer_load_dwordx4 v16, s[16:19], s30 offen lds
  s_add_u32 m0, s94, 34816
  s_add_u32 s30, s8, 16384
  buffer_load_dwordx4 v8, s[12:15], s30 offen lds
  s_add_u32 m0, s94, 35840
  s_add_u32 s30, s8, 24576
  buffer_load_dwordx4 v9, s[12:15], s30 offen lds
  s_waitcnt vmcnt(10)
  s_barrier
  s_add_u32 m0, s95, 61440
  s_add_u32 s30, s9, 98304
  buffer_load_dwordx4 v10, s[16:19], s30 offen lds
  s_add_u32 m0, s95, 63488
  s_add_u32 s30, s9, 99328
  buffer_load_dwordx4 v10, s[16:19], s30 offen lds
  s_add_u32 m0, s95, 65536
  s_add_u32 s30, s9, 100352
  buffer_load_dwordx4 v16, s[16:19], s30 offen lds
  s_waitcnt vmcnt(10)
  s_barrier
  s_add_u32 s97, s96, 7
  s_and_b32 s97, s97, 7
  s_mul_i32 s9, s97, 196608
  s_add_u32 s9, s9, s93
  s_lshl_b32 s97, s97, 7
  s_add_u32 s8, s97, s92
  s_add_u32 m0, s95, 73728
  s_add_u32 s30, s9, 0
  buffer_load_dwordx4 v10, s[16:19], s30 offen lds
  s_add_u32 m0, s94, 49152
  s_add_u32 s30, s8, 0
  buffer_load_dwordx4 v8, s[12:15], s30 offen lds
  s_add_u32 m0, s95, 75776
  s_add_u32 s30, s9, 1024
  buffer_load_dwordx4 v10, s[16:19], s30 offen lds
  s_add_u32 m0, s94, 50176
  s_add_u32 s30, s8, 8192
  buffer_load_dwordx4 v9, s[12:15], s30 offen lds
  s_add_u32 m0, s95, 77824
  s_add_u32 s30, s9, 2048
  buffer_load_dwordx4 v16, s[16:19], s30 offen lds
  s_add_u32 m0, s94, 51200
  s_add_u32 s30, s8, 16384
  buffer_load_dwordx4 v8, s[12:15], s30 offen lds
  s_add_u32 m0, s94, 52224
  s_add_u32 s30, s8, 24576
  buffer_load_dwordx4 v9, s[12:15], s30 offen lds
  s_waitcnt vmcnt(10)
  s_barrier
  s_waitcnt lgkmcnt(0)
  s_mov_b32 s20, s38
  s_mov_b32 s21, s39
  s_mov_b32 s22, 0x1400000
  s_mov_b32 s23, 0x00020000
  s_mov_b32 s48, s44
  s_mov_b32 s49, s45
  s_mov_b32 s50, 0x4000
  s_mov_b32 s51, 0x00020000
  s_bitcmp1_b32 s27, 2
  s_cselect_b32 s52, s56, s46
  s_cselect_b32 s53, s57, s47
  s_mov_b32 s54, 0x80000
  s_mov_b32 s55, 0x00020000
  s_mov_b32 s56, s58
  s_mov_b32 s57, s59
  s_mov_b32 s58, 0x400000
  s_mov_b32 s59, 0x00020000
  s_lshl_b32 s3, s28, 17
  s_add_u32 s3, s3, 2097152
  s_add_u32 s44, s38, s3
  s_addc_u32 s45, s39, 0
  s_mov_b32 s46, 131072
  s_mov_b32 s47, 0x00020000
  s_mov_b32 s38, 256
  s_mov_b32 s39, 0x00020000
  s_mov_b32 s32, 0x0000ffff
  s_mov_b32 s33, 0x0000ffff
  s_mov_b32 s100, 0
  v_mov_b32 v3, 0xdddddddd
  v_mov_b32 v4, 0x7e800000
  v_mov_b32 v2, v1
  s_add_u32 m0, s95, 86016
  s_add_u32 s30, s9, 98304
  buffer_load_dwordx4 v10, s[16:19], s30 offen lds
  s_add_u32 m0, s95, 88064
  s_add_u32 s30, s9, 99328
  buffer_load_dwordx4 v10, s[16:19], s30 offen lds
  s_add_u32 m0, s95, 90112
  s_add_u32 s30, s9, 100352
  buffer_load_dwordx4 v16, s[16:19], s30 offen lds
  s_waitcnt vmcnt(10)
  s_barrier
  s_waitcnt vmcnt(3)
  s_barrier
  s_waitcnt vmcnt(0)
  s_barrier
  s_barrier
  s_mov_b32 s10, 0x200000
nonce1:
  buffer_load_dwordx2 v[6:7], off, s[36:39], 0 sc1
  s_waitcnt vmcnt(0)
  v_readfirstlane_b32 s98, v6
  v_readfirstlane_b32 s99, v7
  s_nop 1
  s_min_u32 s3, s98, s99
  s_cmp_lg_u32 s3, 0
  s_cbranch_scc1 nonce1_ok
  s_sub_u32 s10, s10, 1
  s_cbranch_scc0 nonce1
nonce1_ok:
  s_lshr_b32 s3, s28, 1
  s_lshl_b32 s3, s3, 8
  s_lshl_b32 s3, s3, 4
  s_add_u32 s30, s3, 13631488
  s_mov_b32 s7, s30
  s_lshl_b32 s4, s29, 2
  s_add_u32 s4, s4, s31
  s_lshl_b32 s3, s31, 1
  v_and_b32 v6, 1, v0
  v_add_u32 v6, s3, v6
  s_xor_b32 s3, s25, 1
  s_lshl_b32 s3, s3, 3
  v_and_b32 v7, s3, v0
  v_add_u32 v6, v6, v7
  v_mov_b32 v5, s4
  v_cmp_gt_u32 s[34:35], 32, v0
  s_nop 1
  v_cndmask_b32 v5, v6, v5, s[34:35]
  v_lshlrev_b32 v5, 7, v5
  s_mov_b32 s10, 0x200000
poll2:
  buffer_load_dwordx2 v[6:7], v5, s[20:23], s30 offen sc1
  s_waitcnt vmcnt(0)
  v_cmp_ne_u64 vcc, s[98:99], v[6:7]
  s_nop 3
  s_cbranch_vccz poll2_ok
  s_sub_u32 s10, s10, 1
  s_cbranch_scc0 poll2
poll2_ok:
  s_lshl_b32 s3, s28, 6
  s_lshl_b32 s30, s29, 3
  s_add_u32 s3, s3, s30
  s_lshl_b32 s3, s3, 10
  s_lshl_b32 s30, s31, 11
  s_add_u32 s3, s3, s30
  s_lshl_b32 s30, s31, 13
  s_add_u32 m0, s30, 131072
  s_mov_b32 s4, 0
  buffer_load_dwordx4 v1, s[20:23], s3 offen sc1 lds
  s_add_u32 m0, s30, 134144
  s_nop 0
  buffer_load_dwordx4 v1, s[20:23], s3 offen offset:1024 sc1 lds
  s_lshl_b32 s5, s31, 12
  s_add_u32 m0, s5, 0
  s_add_u32 s3, m0, s4
  s_and_b32 s3, s3, 0x1ffff
  buffer_load_dwordx4 v1, s[44:47], s3 offen offset:0 sc1 lds
  buffer_load_dwordx4 v1, s[44:47], s3 offen offset:1024 sc1 lds
  buffer_load_dwordx4 v1, s[44:47], s3 offen offset:2048 sc1 lds
  buffer_load_dwordx4 v1, s[44:47], s3 offen offset:3072 sc1 lds
  s_cmp_eq_u32 s25, 0
  s_cbranch_scc0 no_r1
  s_add_u32 m0, s5, 16384
  s_add_u32 s3, m0, s4
  s_and_b32 s3, s3, 0x1ffff
  buffer_load_dwordx4 v1, s[44:47], s3 offen offset:0 sc1 lds
  buffer_load_dwordx4 v1, s[44:47], s3 offen offset:1024 sc1 lds
  buffer_load_dwordx4 v1, s[44:47], s3 offen offset:2048 sc1 lds
  buffer_load_dwordx4 v1, s[44:47], s3 offen offset:3072 sc1 lds
no_r1:
  s_lshr_b32 s3, s31, 1
  s_lshl_b32 s3, s3, 3
  s_and_b32 s6, s31, 1
  s_add_u32 s3, s3, s6
  s_lshl_b32 s6, s11, 1
  s_add_u32 s3, s3, s6
  s_lshl_b32 s3, s3, 12
  s_add_u32 s6, s3, 14286848
  s_and_b32 s3, s24, 3
  s_lshl_b32 s3, s3, 1
  v_and_b32 v5, 1, v0
  v_bfe_u32 v6, v0, 1, 2
  v_lshl_add_u32 v5, v6, 3, v5
  v_add_u32 v5, s3, v5
  v_lshlrev_b32 v5, 7, v5
  buffer_load_dwordx2 v[102:103], v5, s[20:23], s7 offen sc1
  v_mov_b32 v84, 0x3f803f80
  v_mov_b32 v85, 0x3f803f80
  v_mov_b64 v[86:87], v[84:85]
  v_mov_b64 v[88:89], v[84:85]
  v_mov_b64 v[90:91], v[84:85]
  v_mov_b64 v[92:93], v[84:85]
  v_mov_b64 v[94:95], v[84:85]
  v_mov_b64 v[96:97], v[84:85]
  v_mov_b64 v[98:99], v[84:85]
  v_mov_b64 v[60:61], 0
  v_mov_b64 v[62:63], 0
  v_mov_b64 v[64:65], 0
  v_mov_b64 v[66:67], 0
  v_mov_b64 v[68:69], 0
  v_mov_b64 v[70:71], 0
  v_mov_b64 v[72:73], 0
  v_mov_b64 v[74:75], 0
  s_lshl_b32 s3, s24, 12
  s_add_u32 s3, s3, 131072
  v_add_u32 v5, s3, v1
  s_waitcnt vmcnt(5)
  s_cmp_eq_u32 s25, 0
  s_cbranch_scc1 no_w1
  s_waitcnt vmcnt(1)
no_w1:
  s_barrier
  ds_read_b128 v[8:11], v5
  ds_read_b128 v[76:79], v2
  ds_read_b128 v[80:83], v2 offset:2048
  s_mov_b64 exec, s[32:33]
  ds_read_b128 v[84:87], v2 offset:1024
  ds_read_b128 v[88:91], v2 offset:1280
  s_mov_b64 exec, -1
  s_branch after_x
comp_setup:
  s_and_b32 s3, s2, 7
  s_lshr_b32 s30, s2, 3
  s_and_b32 s10, s30, 7
  s_lshl_b32 s101, s3, 3
  s_add_u32 s101, s101, s10
  s_lshr_b32 s11, s30, 3
  s_lshl_b32 s28, s3, 2
  s_and_b32 s10, s30, 3
  s_add_u32 s28, s28, s10
  s_lshr_b32 s29, s30, 2
  v_lshlrev_b32 v1, 4, v0
  s_waitcnt lgkmcnt(0)
  s_mov_b32 s20, s38
  s_mov_b32 s21, s39
  s_mov_b32 s22, 0x1400000
  s_mov_b32 s23, 0x00020000
  s_mov_b32 s48, s44
  s_mov_b32 s49, s45
  s_mov_b32 s50, 0x4000
  s_mov_b32 s51, 0x00020000
  s_bitcmp1_b32 s27, 2
  s_cselect_b32 s52, s56, s46
  s_cselect_b32 s53, s57, s47
  s_mov_b32 s54, 0x80000
  s_mov_b32 s55, 0x00020000
  s_mov_b32 s56, s58
  s_mov_b32 s57, s59
  s_mov_b32 s58, 0x400000
  s_mov_b32 s59, 0x00020000
  s_lshl_b32 s3, s28, 17
  s_add_u32 s3, s3, 2097152
  s_add_u32 s44, s38, s3
  s_addc_u32 s45, s39, 0
  s_mov_b32 s46, 131072
  s_mov_b32 s47, 0x00020000
  s_mov_b32 s38, 256
  s_mov_b32 s39, 0x00020000
  s_mov_b32 s32, 0x0000ffff
  s_mov_b32 s33, 0x0000ffff
  s_mov_b32 s100, 0
  v_mov_b32 v3, 0xdddddddd
  v_mov_b32 v4, 0x7e800000
  v_mov_b32 v2, v1
  s_or_b32 s3, s2, s24
  s_cmp_lg_u32 s3, 0
  s_cbranch_scc1 no_epoch
  s_mov_b32 s3, 14221312
  buffer_load_dwordx2 v[6:7], off, s[20:23], s3 sc1
  s_waitcnt vmcnt(0)
  v_add_u32 v6, 1, v6
  v_max_u32 v6, 1, v6
  v_or_b32 v7, 0x80000000, v7
  s_mov_b64 exec, 1
  buffer_store_dwordx2 v[6:7], off, s[36:39], 0 sc1
  buffer_store_dwordx2 v[6:7], off, s[20:23], s3 sc1
  s_mov_b64 exec, -1
no_epoch:
  s_and_b32 s4, s24, 1
  s_lshr_b32 s5, s24, 1
  v_and_b32 v8, 15, v0
  v_lshrrev_b32 v6, 5, v0
  v_lshrrev_b32 v10, 4, v0
  v_bfe_u32 v7, v0, 1, 3
  v_xor_b32 v7, v7, v10
  s_lshl_b32 s3, s4, 13
  v_lshl_add_u32 v8, v8, 7, s3
  v_xor_b32 v9, 0, v7
  v_lshl_add_u32 v48, v9, 4, v8
  v_xor_b32 v9, 4, v7
  v_lshl_add_u32 v49, v9, 4, v8
  v_bfe_u32 v7, v0, 4, 1
  v_bfe_u32 v8, v0, 2, 2
  v_lshl_add_u32 v9, v7, 3, v8
  v_lshlrev_b32 v9, 7, v9
  v_mul_u32_u24 v10, 6144, v6
  v_add_u32 v9, v9, v10
  v_add_u32 v9, 65536, v9
  v_lshrrev_b32 v8, 1, v8
  v_lshlrev_b32 v7, 2, v7
  s_lshl_b32 s3, s5, 2
  v_xor_b32 v7, s3, v7
  v_and_b32 v10, 1, v0
  v_lshlrev_b32 v10, 1, v10
  v_xor_b32 v10, v10, v7
  v_xor_b32 v10, v10, v8
  v_lshl_add_u32 v10, v10, 4, v9
  v_bfe_u32 v11, v0, 1, 1
  v_lshl_add_u32 v50, v11, 3, v10
  v_xor_b32 v52, 16, v50
  v_lshlrev_b32 v8, 1, v8
  v_xor_b32 v10, v11, v7
  v_xor_b32 v10, v10, v8
  v_lshl_add_u32 v10, v10, 4, v9
  v_and_b32 v11, 1, v0
  v_lshl_add_u32 v10, v11, 3, v10
  v_add_u32 v54, 4096, v10
  v_xor_b32 v56, 32, v54
  v_add_u32 v51, 49152, v50
  v_add_u32 v53, 49152, v52
  v_add_u32 v55, 49152, v54
  v_add_u32 v57, 49152, v56
  s_lshl_b32 s3, s5, 1
  s_lshl_b32 s6, s26, 2
  s_lshl_b32 s10, s4, 1
  s_add_u32 s6, s6, s10
  s_lshl_b32 s7, s27, 2
  s_add_u32 s7, s7, s3
  v_mov_b32 v119, 0
  v_mov_b32 v124, 0
  s_mov_b32 s43, 0
  v_and_b32 v7, 15, v0
  v_lshlrev_b32 v7, 4, v7
  v_lshl_add_u32 v7, v6, 9, v7
  v_bfe_u32 v8, v0, 4, 1
  v_lshl_add_u32 v59, v8, 17, v7
  v_lshl_add_u32 v58, v8, 16, v7
  s_cmp_eq_u32 s25, 0
  s_cbranch_scc0 setup_b
  s_lshl_b32 s10, s24, 10
  s_add_u32 s10, s10, 49152
  s_mov_b32 m0, s10
  s_lshl_b32 s43, s7, 9
  buffer_load_dwordx4 v1, s[48:51], s43 offen lds
  v_bfe_u32 v7, v0, 2, 2
  v_lshlrev_b32 v7, 5, v7
  v_lshl_add_u32 v7, v6, 7, v7
  v_bfe_u32 v8, v0, 4, 1
  v_lshl_add_u32 v7, v8, 4, v7
  v_bfe_u32 v8, v0, 1, 1
  v_lshl_add_u32 v7, v8, 3, v7
  v_add_u32 v124, s10, v7
  v_bfe_i32 v119, v0, 2, 1
  v_and_b32 v119, 0x80008000, v119
  v_and_b32 v8, 31, v0
  v_lshlrev_b32 v9, 2, v6
  v_sub_u32 v8, v8, v9
  v_mov_b32 v9, 0x3f80
  v_subrev_u32 v108, 0, v8
  v_cmp_gt_u32 s[34:35], 2, v108
  v_lshlrev_b32 v108, 4, v108
  v_lshlrev_b32 v108, v108, v9
  v_cndmask_b32 v108, 0, v108, s[34:35]
  v_subrev_u32 v109, 2, v8
  v_cmp_gt_u32 s[34:35], 2, v109
  v_lshlrev_b32 v109, 4, v109
  v_lshlrev_b32 v109, v109, v9
  v_cndmask_b32 v109, 0, v109, s[34:35]
  v_subrev_u32 v110, 8, v8
  v_cmp_gt_u32 s[34:35], 2, v110
  v_lshlrev_b32 v110, 4, v110
  v_lshlrev_b32 v110, v110, v9
  v_cndmask_b32 v110, 0, v110, s[34:35]
  v_subrev_u32 v111, 10, v8
  v_cmp_gt_u32 s[34:35], 2, v111
  v_lshlrev_b32 v111, 4, v111
  v_lshlrev_b32 v111, v111, v9
  v_cndmask_b32 v111, 0, v111, s[34:35]
  v_subrev_u32 v112, 16, v8
  v_cmp_gt_u32 s[34:35], 2, v112
  v_lshlrev_b32 v112, 4, v112
  v_lshlrev_b32 v112, v112, v9
  v_cndmask_b32 v112, 0, v112, s[34:35]
  v_subrev_u32 v113, 18, v8
  v_cmp_gt_u32 s[34:35], 2, v113
  v_lshlrev_b32 v113, 4, v113
  v_lshlrev_b32 v113, v113, v9
  v_cndmask_b32 v113, 0, v113, s[34:35]
  v_subrev_u32 v114, 24, v8
  v_cmp_gt_u32 s[34:35], 2, v114
  v_lshlrev_b32 v114, 4, v114
  v_lshlrev_b32 v114, v114, v9
  v_cndmask_b32 v114, 0, v114, s[34:35]
  v_subrev_u32 v115, 26, v8
  v_cmp_gt_u32 s[34:35], 2, v115
  v_lshlrev_b32 v115, 4, v115
  v_lshlrev_b32 v115, v115, v9
  v_cndmask_b32 v115, 0, v115, s[34:35]
  v_mov_b32 v116, 0x3fb8aa3b
  v_bfe_u32 v117, v0, 4, 1
  v_add_u32 v117, -1, v117
  v_mov_b32 v118, 0x3f803f80
  s_branch gemm
setup_b:
  s_lshl_b32 s40, s7, 16
  s_lshl_b32 s10, s6, 10
  s_add_u32 s40, s40, s10
  s_lshl_b32 s41, s7, 17
  s_add_u32 s41, s41, 2097152
  s_lshl_b32 s3, s6, 10
  s_add_u32 s41, s41, s3
  s_add_u32 s9, s41, 65536
  v_mov_b32 v116, 0x3eb8aa3b
  s_lshr_b32 s3, s6, 1
  s_lshl_b32 s42, s7, 15
  s_lshl_b32 s10, s3, 10
  s_add_u32 s42, s42, s10
  s_add_u32 s42, s42, 14680064
  s_lshl_b32 s3, s3, 14
  s_and_b32 s10, s7, 15
  s_lshl_b32 s10, s10, 6
  s_add_u32 s43, s3, s10
  v_lshrrev_b32 v7, 3, v0
  v_and_b32 v8, 7, v0
  v_lshlrev_b32 v8, 4, v8
  v_lshl_add_u32 v124, v7, 10, v8
  s_lshl_b32 s8, s24, 11
  s_add_u32 s8, s8, 65536
  v_bfe_u32 v7, v0, 2, 2
  v_lshl_add_u32 v7, v6, 2, v7
  v_lshlrev_b32 v7, 7, v7
  v_and_b32 v8, 1, v0
  v_lshl_add_u32 v7, v8, 5, v7
  v_bfe_u32 v8, v0, 4, 1
  v_lshl_add_u32 v7, v8, 4, v7
  v_bfe_u32 v8, v0, 1, 1
  v_lshl_add_u32 v7, v8, 3, v7
  v_add_u32 v119, s8, v7
gemm:
  s_barrier
  ds_read_b128 v[8:11], v48 offset:0
  ds_read_b128 v[12:15], v48 offset:2048
  ds_read_b128 v[16:19], v48 offset:4096
  ds_read_b128 v[20:23], v48 offset:6144
  ds_read_b64_tr_b16 v[24:25], v50 offset:0
  ds_read_b64_tr_b16 v[26:27], v50 offset:512
  ds_read_b64_tr_b16 v[28:29], v52 offset:0
  ds_read_b64_tr_b16 v[30:31], v52 offset:512
  ds_read_b64_tr_b16 v[32:33], v50 offset:2048
  ds_read_b64_tr_b16 v[34:35], v50 offset:2560
  ds_read_b64_tr_b16 v[36:37], v52 offset:2048
  ds_read_b64_tr_b16 v[38:39], v52 offset:2560
  ds_read_b64_tr_b16 v[40:41], v54 offset:0
  ds_read_b64_tr_b16 v[42:43], v54 offset:512
  ds_read_b64_tr_b16 v[44:45], v56 offset:0
  ds_read_b64_tr_b16 v[46:47], v56 offset:512
  s_waitcnt lgkmcnt(0)
  s_barrier
  v_mfma_f32_16x16x32_bf16 v[160:163], v[24:27], v[8:11], 0
  ds_read_b128 v[60:63], v49 offset:0
  v_mfma_f32_16x16x32_bf16 v[168:171], v[24:27], v[12:15], 0
  ds_read_b128 v[64:67], v49 offset:2048
  v_mfma_f32_16x16x32_bf16 v[176:179], v[24:27], v[16:19], 0
  ds_read_b128 v[68:71], v49 offset:4096
  v_mfma_f32_16x16x32_bf16 v[184:187], v[24:27], v[20:23], 0
  ds_read_b128 v[72:75], v49 offset:6144
  v_mfma_f32_16x16x32_bf16 v[164:167], v[28:31], v[8:11], 0
  ds_read_b64_tr_b16 v[76:77], v50 offset:12288
  v_mfma_f32_16x16x32_bf16 v[172:175], v[28:31], v[12:15], 0
  ds_read_b64_tr_b16 v[78:79], v50 offset:12800
  v_mfma_f32_16x16x32_bf16 v[180:183], v[28:31], v[16:19], 0
  ds_read_b64_tr_b16 v[80:81], v52 offset:12288
  v_mfma_f32_16x16x32_bf16 v[188:191], v[28:31], v[20:23], 0
  ds_read_b64_tr_b16 v[82:83], v52 offset:12800
  v_mfma_f32_16x16x32_bf16 v[192:195], v[32:35], v[8:11], 0
  ds_read_b64_tr_b16 v[84:85], v50 offset:14336
  v_mfma_f32_16x16x32_bf16 v[200:203], v[32:35], v[12:15], 0
  ds_read_b64_tr_b16 v[86:87], v50 offset:14848
  v_mfma_f32_16x16x32_bf16 v[208:211], v[32:35], v[16:19], 0
  ds_read_b64_tr_b16 v[88:89], v52 offset:14336
  v_mfma_f32_16x16x32_bf16 v[216:219], v[32:35], v[20:23], 0
  ds_read_b64_tr_b16 v[90:91], v52 offset:14848
  v_mfma_f32_16x16x32_bf16 v[196:199], v[36:39], v[8:11], 0
  ds_read_b64_tr_b16 v[92:93], v54 offset:12288
  v_mfma_f32_16x16x32_bf16 v[204:207], v[36:39], v[12:15], 0
  ds_read_b64_tr_b16 v[94:95], v54 offset:12800
  v_mfma_f32_16x16x32_bf16 v[212:215], v[36:39], v[16:19], 0
  ds_read_b64_tr_b16 v[96:97], v56 offset:12288
  v_mfma_f32_16x16x32_bf16 v[220:223], v[36:39], v[20:23], 0
  ds_read_b64_tr_b16 v[98:99], v56 offset:12800
  v_mfma_f32_16x16x32_bf16 v[224:227], v[8:11], v[40:43], 0
  v_mfma_f32_16x16x32_bf16 v[232:235], v[12:15], v[40:43], 0
  s_cmp_eq_u32 s25, 0
  s_cbranch_scc0 no_wphi
  s_waitcnt vmcnt(0)
  ds_read_b64_tr_b16 v[100:101], v124 offset:0
  ds_read_b64_tr_b16 v[102:103], v124 offset:256
  ds_read_b64_tr_b16 v[104:105], v124 offset:512
  ds_read_b64_tr_b16 v[106:107], v124 offset:768
no_wphi:
  v_mfma_f32_16x16x32_bf16 v[240:243], v[16:19], v[40:43], 0
  v_mfma_f32_16x16x32_bf16 v[248:251], v[20:23], v[40:43], 0
  v_mfma_f32_16x16x32_bf16 v[228:231], v[8:11], v[44:47], 0
  v_mfma_f32_16x16x32_bf16 v[236:239], v[12:15], v[44:47], 0
  v_mfma_f32_16x16x32_bf16 v[244:247], v[16:19], v[44:47], 0
  v_mfma_f32_16x16x32_bf16 v[252:255], v[20:23], v[44:47], 0
  s_waitcnt lgkmcnt(0)
  s_barrier
  v_mfma_f32_16x16x32_bf16 v[160:163], v[76:79], v[60:63], v[160:163]
  ds_read_b128 v[8:11], v48 offset:16384
  v_mfma_f32_16x16x32_bf16 v[168:171], v[76:79], v[64:67], v[168:171]
  ds_read_b128 v[12:15], v48 offset:18432
  v_mfma_f32_16x16x32_bf16 v[176:179], v[76:79], v[68:71], v[176:179]
  ds_read_b128 v[16:19], v48 offset:20480
  v_mfma_f32_16x16x32_bf16 v[184:187], v[76:79], v[72:75], v[184:187]
  ds_read_b128 v[20:23], v48 offset:22528
  v_mfma_f32_16x16x32_bf16 v[164:167], v[80:83], v[60:63], v[164:167]
  ds_read_b64_tr_b16 v[24:25], v50 offset:24576
  v_mfma_f32_16x16x32_bf16 v[172:175], v[80:83], v[64:67], v[172:175]
  ds_read_b64_tr_b16 v[26:27], v50 offset:25088
  v_mfma_f32_16x16x32_bf16 v[180:183], v[80:83], v[68:71], v[180:183]
  ds_read_b64_tr_b16 v[28:29], v52 offset:24576
  v_mfma_f32_16x16x32_bf16 v[188:191], v[80:83], v[72:75], v[188:191]
  ds_read_b64_tr_b16 v[30:31], v52 offset:25088
  v_mfma_f32_16x16x32_bf16 v[192:195], v[84:87], v[60:63], v[192:195]
  ds_read_b64_tr_b16 v[32:33], v50 offset:26624
  v_mfma_f32_16x16x32_bf16 v[200:203], v[84:87], v[64:67], v[200:203]
  ds_read_b64_tr_b16 v[34:35], v50 offset:27136
  v_mfma_f32_16x16x32_bf16 v[208:211], v[84:87], v[68:71], v[208:211]
  ds_read_b64_tr_b16 v[36:37], v52 offset:26624
  v_mfma_f32_16x16x32_bf16 v[216:219], v[84:87], v[72:75], v[216:219]
  ds_read_b64_tr_b16 v[38:39], v52 offset:27136
  v_mfma_f32_16x16x32_bf16 v[196:199], v[88:91], v[60:63], v[196:199]
  ds_read_b64_tr_b16 v[40:41], v54 offset:24576
  v_mfma_f32_16x16x32_bf16 v[204:207], v[88:91], v[64:67], v[204:207]
  ds_read_b64_tr_b16 v[42:43], v54 offset:25088
  v_mfma_f32_16x16x32_bf16 v[212:215], v[88:91], v[68:71], v[212:215]
  ds_read_b64_tr_b16 v[44:45], v56 offset:24576
  v_mfma_f32_16x16x32_bf16 v[220:223], v[88:91], v[72:75], v[220:223]
  ds_read_b64_tr_b16 v[46:47], v56 offset:25088
  v_mfma_f32_16x16x32_bf16 v[224:227], v[60:63], v[92:95], v[224:227]
  v_mfma_f32_16x16x32_bf16 v[232:235], v[64:67], v[92:95], v[232:235]
  v_mfma_f32_16x16x32_bf16 v[240:243], v[68:71], v[92:95], v[240:243]
  v_mfma_f32_16x16x32_bf16 v[248:251], v[72:75], v[92:95], v[248:251]
  v_mfma_f32_16x16x32_bf16 v[228:231], v[60:63], v[96:99], v[228:231]
  v_mfma_f32_16x16x32_bf16 v[236:239], v[64:67], v[96:99], v[236:239]
  v_mfma_f32_16x16x32_bf16 v[244:247], v[68:71], v[96:99], v[244:247]
  v_mfma_f32_16x16x32_bf16 v[252:255], v[72:75], v[96:99], v[252:255]
  s_waitcnt lgkmcnt(0)
  s_barrier
  v_mfma_f32_16x16x32_bf16 v[160:163], v[24:27], v[8:11], v[160:163]
  ds_read_b128 v[60:63], v49 offset:16384
  v_mfma_f32_16x16x32_bf16 v[168:171], v[24:27], v[12:15], v[168:171]
  ds_read_b128 v[64:67], v49 offset:18432
  v_mfma_f32_16x16x32_bf16 v[176:179], v[24:27], v[16:19], v[176:179]
  ds_read_b128 v[68:71], v49 offset:20480
  v_mfma_f32_16x16x32_bf16 v[184:187], v[24:27], v[20:23], v[184:187]
  ds_read_b128 v[72:75], v49 offset:22528
  v_mfma_f32_16x16x32_bf16 v[164:167], v[28:31], v[8:11], v[164:167]
  ds_read_b64_tr_b16 v[76:77], v50 offset:36864
  v_mfma_f32_16x16x32_bf16 v[172:175], v[28:31], v[12:15], v[172:175]
  ds_read_b64_tr_b16 v[78:79], v50 offset:37376
  v_mfma_f32_16x16x32_bf16 v[180:183], v[28:31], v[16:19], v[180:183]
  ds_read_b64_tr_b16 v[80:81], v52 offset:36864
  v_mfma_f32_16x16x32_bf16 v[188:191], v[28:31], v[20:23], v[188:191]
  ds_read_b64_tr_b16 v[82:83], v52 offset:37376
  v_mfma_f32_16x16x32_bf16 v[192:195], v[32:35], v[8:11], v[192:195]
  ds_read_b64_tr_b16 v[84:85], v50 offset:38912
  v_mfma_f32_16x16x32_bf16 v[200:203], v[32:35], v[12:15], v[200:203]
  ds_read_b64_tr_b16 v[86:87], v50 offset:39424
  v_mfma_f32_16x16x32_bf16 v[208:211], v[32:35], v[16:19], v[208:211]
  ds_read_b64_tr_b16 v[88:89], v52 offset:38912
  v_mfma_f32_16x16x32_bf16 v[216:219], v[32:35], v[20:23], v[216:219]
  ds_read_b64_tr_b16 v[90:91], v52 offset:39424
  v_mfma_f32_16x16x32_bf16 v[196:199], v[36:39], v[8:11], v[196:199]
  ds_read_b64_tr_b16 v[92:93], v54 offset:36864
  v_mfma_f32_16x16x32_bf16 v[204:207], v[36:39], v[12:15], v[204:207]
  ds_read_b64_tr_b16 v[94:95], v54 offset:37376
  v_mfma_f32_16x16x32_bf16 v[212:215], v[36:39], v[16:19], v[212:215]
  ds_read_b64_tr_b16 v[96:97], v56 offset:36864
  v_mfma_f32_16x16x32_bf16 v[220:223], v[36:39], v[20:23], v[220:223]
  ds_read_b64_tr_b16 v[98:99], v56 offset:37376
  v_mfma_f32_16x16x32_bf16 v[224:227], v[8:11], v[40:43], v[224:227]
  v_xor_b32 v100, v119, v100
  v_mfma_f32_16x16x32_bf16 v[232:235], v[12:15], v[40:43], v[232:235]
  v_xor_b32 v101, v119, v101
  v_mfma_f32_16x16x32_bf16 v[240:243], v[16:19], v[40:43], v[240:243]
  v_xor_b32 v102, v119, v102
  v_mfma_f32_16x16x32_bf16 v[248:251], v[20:23], v[40:43], v[248:251]
  v_xor_b32 v103, v119, v103
  v_mfma_f32_16x16x32_bf16 v[228:231], v[8:11], v[44:47], v[228:231]
  v_xor_b32 v104, v119, v104
  v_mfma_f32_16x16x32_bf16 v[236:239], v[12:15], v[44:47], v[236:239]
  v_xor_b32 v105, v119, v105
  v_mfma_f32_16x16x32_bf16 v[244:247], v[16:19], v[44:47], v[244:247]
  v_xor_b32 v106, v119, v106
  v_mfma_f32_16x16x32_bf16 v[252:255], v[20:23], v[44:47], v[252:255]
  v_xor_b32 v107, v119, v107
  s_waitcnt lgkmcnt(0)
  s_barrier
  v_mfma_f32_16x16x32_bf16 v[160:163], v[76:79], v[60:63], v[160:163]
  ds_read_b128 v[8:11], v48 offset:32768
  v_mfma_f32_16x16x32_bf16 v[168:171], v[76:79], v[64:67], v[168:171]
  ds_read_b128 v[12:15], v48 offset:34816
  v_mfma_f32_16x16x32_bf16 v[176:179], v[76:79], v[68:71], v[176:179]
  ds_read_b128 v[16:19], v48 offset:36864
  v_mfma_f32_16x16x32_bf16 v[184:187], v[76:79], v[72:75], v[184:187]
  ds_read_b128 v[20:23], v48 offset:38912
  v_mfma_f32_16x16x32_bf16 v[164:167], v[80:83], v[60:63], v[164:167]
  ds_read_b64_tr_b16 v[24:25], v51 offset:0
  v_mfma_f32_16x16x32_bf16 v[172:175], v[80:83], v[64:67], v[172:175]
  ds_read_b64_tr_b16 v[26:27], v51 offset:512
  v_mfma_f32_16x16x32_bf16 v[180:183], v[80:83], v[68:71], v[180:183]
  ds_read_b64_tr_b16 v[28:29], v53 offset:0
  v_mfma_f32_16x16x32_bf16 v[188:191], v[80:83], v[72:75], v[188:191]
  ds_read_b64_tr_b16 v[30:31], v53 offset:512
  v_mfma_f32_16x16x32_bf16 v[192:195], v[84:87], v[60:63], v[192:195]
  ds_read_b64_tr_b16 v[32:33], v51 offset:2048
  v_mfma_f32_16x16x32_bf16 v[200:203], v[84:87], v[64:67], v[200:203]
  ds_read_b64_tr_b16 v[34:35], v51 offset:2560
  v_mfma_f32_16x16x32_bf16 v[208:211], v[84:87], v[68:71], v[208:211]
  ds_read_b64_tr_b16 v[36:37], v53 offset:2048
  v_mfma_f32_16x16x32_bf16 v[216:219], v[84:87], v[72:75], v[216:219]
  ds_read_b64_tr_b16 v[38:39], v53 offset:2560
  v_mfma_f32_16x16x32_bf16 v[196:199], v[88:91], v[60:63], v[196:199]
  ds_read_b64_tr_b16 v[40:41], v55 offset:0
  v_mfma_f32_16x16x32_bf16 v[204:207], v[88:91], v[64:67], v[204:207]
  ds_read_b64_tr_b16 v[42:43], v55 offset:512
  v_mfma_f32_16x16x32_bf16 v[212:215], v[88:91], v[68:71], v[212:215]
  ds_read_b64_tr_b16 v[44:45], v57 offset:0
  v_mfma_f32_16x16x32_bf16 v[220:223], v[88:91], v[72:75], v[220:223]
  ds_read_b64_tr_b16 v[46:47], v57 offset:512
  v_mfma_f32_16x16x32_bf16 v[224:227], v[60:63], v[92:95], v[224:227]
  v_mfma_f32_16x16x32_bf16 v[232:235], v[64:67], v[92:95], v[232:235]
  v_mfma_f32_16x16x32_bf16 v[240:243], v[68:71], v[92:95], v[240:243]
  v_mfma_f32_16x16x32_bf16 v[248:251], v[72:75], v[92:95], v[248:251]
  v_mfma_f32_16x16x32_bf16 v[228:231], v[60:63], v[96:99], v[228:231]
  v_mfma_f32_16x16x32_bf16 v[236:239], v[64:67], v[96:99], v[236:239]
  v_mfma_f32_16x16x32_bf16 v[244:247], v[68:71], v[96:99], v[244:247]
  v_mfma_f32_16x16x32_bf16 v[252:255], v[72:75], v[96:99], v[252:255]
  s_waitcnt lgkmcnt(0)
  s_barrier
  v_mfma_f32_16x16x32_bf16 v[160:163], v[24:27], v[8:11], v[160:163]
  ds_read_b128 v[60:63], v49 offset:32768
  v_mfma_f32_16x16x32_bf16 v[168:171], v[24:27], v[12:15], v[168:171]
  ds_read_b128 v[64:67], v49 offset:34816
  v_mfma_f32_16x16x32_bf16 v[176:179], v[24:27], v[16:19], v[176:179]
  ds_read_b128 v[68:71], v49 offset:36864
  v_mfma_f32_16x16x32_bf16 v[184:187], v[24:27], v[20:23], v[184:187]
  ds_read_b128 v[72:75], v49 offset:38912
  v_mfma_f32_16x16x32_bf16 v[164:167], v[28:31], v[8:11], v[164:167]
  ds_read_b64_tr_b16 v[76:77], v51 offset:12288
  v_mfma_f32_16x16x32_bf16 v[172:175], v[28:31], v[12:15], v[172:175]
  ds_read_b64_tr_b16 v[78:79], v51 offset:12800
  v_mfma_f32_16x16x32_bf16 v[180:183], v[28:31], v[16:19], v[180:183]
  ds_read_b64_tr_b16 v[80:81], v53 offset:12288
  v_mfma_f32_16x16x32_bf16 v[188:191], v[28:31], v[20:23], v[188:191]
  ds_read_b64_tr_b16 v[82:83], v53 offset:12800
  v_mfma_f32_16x16x32_bf16 v[192:195], v[32:35], v[8:11], v[192:195]
  ds_read_b64_tr_b16 v[84:85], v51 offset:14336
  v_mfma_f32_16x16x32_bf16 v[200:203], v[32:35], v[12:15], v[200:203]
  ds_read_b64_tr_b16 v[86:87], v51 offset:14848
  v_mfma_f32_16x16x32_bf16 v[208:211], v[32:35], v[16:19], v[208:211]
  ds_read_b64_tr_b16 v[88:89], v53 offset:14336
  v_mfma_f32_16x16x32_bf16 v[216:219], v[32:35], v[20:23], v[216:219]
  ds_read_b64_tr_b16 v[90:91], v53 offset:14848
  v_mfma_f32_16x16x32_bf16 v[196:199], v[36:39], v[8:11], v[196:199]
  ds_read_b64_tr_b16 v[92:93], v55 offset:12288
  v_mfma_f32_16x16x32_bf16 v[204:207], v[36:39], v[12:15], v[204:207]
  ds_read_b64_tr_b16 v[94:95], v55 offset:12800
  v_mfma_f32_16x16x32_bf16 v[212:215], v[36:39], v[16:19], v[212:215]
  ds_read_b64_tr_b16 v[96:97], v57 offset:12288
  v_mfma_f32_16x16x32_bf16 v[220:223], v[36:39], v[20:23], v[220:223]
  ds_read_b64_tr_b16 v[98:99], v57 offset:12800
  v_mfma_f32_16x16x32_bf16 v[224:227], v[8:11], v[40:43], v[224:227]
  v_mfma_f32_16x16x32_bf16 v[232:235], v[12:15], v[40:43], v[232:235]
  v_mfma_f32_16x16x32_bf16 v[240:243], v[16:19], v[40:43], v[240:243]
  v_mfma_f32_16x16x32_bf16 v[248:251], v[20:23], v[40:43], v[248:251]
  v_mfma_f32_16x16x32_bf16 v[228:231], v[8:11], v[44:47], v[228:231]
  v_mfma_f32_16x16x32_bf16 v[236:239], v[12:15], v[44:47], v[236:239]
  v_mfma_f32_16x16x32_bf16 v[244:247], v[16:19], v[44:47], v[244:247]
  v_mfma_f32_16x16x32_bf16 v[252:255], v[20:23], v[44:47], v[252:255]
  s_waitcnt lgkmcnt(0)
  s_barrier
  v_mfma_f32_16x16x32_bf16 v[160:163], v[76:79], v[60:63], v[160:163]
  ds_read_b128 v[8:11], v48 offset:49152
  v_mfma_f32_16x16x32_bf16 v[168:171], v[76:79], v[64:67], v[168:171]
  ds_read_b128 v[12:15], v48 offset:51200
  v_mfma_f32_16x16x32_bf16 v[176:179], v[76:79], v[68:71], v[176:179]
  ds_read_b128 v[16:19], v48 offset:53248
  v_mfma_f32_16x16x32_bf16 v[184:187], v[76:79], v[72:75], v[184:187]
  ds_read_b128 v[20:23], v48 offset:55296
  v_mfma_f32_16x16x32_bf16 v[164:167], v[80:83], v[60:63], v[164:167]
  ds_read_b64_tr_b16 v[24:25], v51 offset:24576
  v_mfma_f32_16x16x32_bf16 v[172:175], v[80:83], v[64:67], v[172:175]
  ds_read_b64_tr_b16 v[26:27], v51 offset:25088
  v_mfma_f32_16x16x32_bf16 v[180:183], v[80:83], v[68:71], v[180:183]
  ds_read_b64_tr_b16 v[28:29], v53 offset:24576
  v_mfma_f32_16x16x32_bf16 v[188:191], v[80:83], v[72:75], v[188:191]
  ds_read_b64_tr_b16 v[30:31], v53 offset:25088
  v_mfma_f32_16x16x32_bf16 v[192:195], v[84:87], v[60:63], v[192:195]
  ds_read_b64_tr_b16 v[32:33], v51 offset:26624
  v_mfma_f32_16x16x32_bf16 v[200:203], v[84:87], v[64:67], v[200:203]
  ds_read_b64_tr_b16 v[34:35], v51 offset:27136
  v_mfma_f32_16x16x32_bf16 v[208:211], v[84:87], v[68:71], v[208:211]
  ds_read_b64_tr_b16 v[36:37], v53 offset:26624
  v_mfma_f32_16x16x32_bf16 v[216:219], v[84:87], v[72:75], v[216:219]
  ds_read_b64_tr_b16 v[38:39], v53 offset:27136
  v_mfma_f32_16x16x32_bf16 v[196:199], v[88:91], v[60:63], v[196:199]
  ds_read_b64_tr_b16 v[40:41], v55 offset:24576
  v_mfma_f32_16x16x32_bf16 v[204:207], v[88:91], v[64:67], v[204:207]
  ds_read_b64_tr_b16 v[42:43], v55 offset:25088
  v_mfma_f32_16x16x32_bf16 v[212:215], v[88:91], v[68:71], v[212:215]
  ds_read_b64_tr_b16 v[44:45], v57 offset:24576
  v_mfma_f32_16x16x32_bf16 v[220:223], v[88:91], v[72:75], v[220:223]
  ds_read_b64_tr_b16 v[46:47], v57 offset:25088
  v_mfma_f32_16x16x32_bf16 v[224:227], v[60:63], v[92:95], v[224:227]
  v_mfma_f32_16x16x32_bf16 v[232:235], v[64:67], v[92:95], v[232:235]
  v_mfma_f32_16x16x32_bf16 v[240:243], v[68:71], v[92:95], v[240:243]
  v_mfma_f32_16x16x32_bf16 v[248:251], v[72:75], v[92:95], v[248:251]
  v_mfma_f32_16x16x32_bf16 v[228:231], v[60:63], v[96:99], v[228:231]
  v_mfma_f32_16x16x32_bf16 v[236:239], v[64:67], v[96:99], v[236:239]
  v_mfma_f32_16x16x32_bf16 v[244:247], v[68:71], v[96:99], v[244:247]
  v_mfma_f32_16x16x32_bf16 v[252:255], v[72:75], v[96:99], v[252:255]
  s_waitcnt lgkmcnt(0)
  s_barrier
  v_mfma_f32_16x16x32_bf16 v[160:163], v[24:27], v[8:11], v[160:163]
  ds_read_b128 v[60:63], v49 offset:49152
  v_mfma_f32_16x16x32_bf16 v[168:171], v[24:27], v[12:15], v[168:171]
  ds_read_b128 v[64:67], v49 offset:51200
  v_mfma_f32_16x16x32_bf16 v[176:179], v[24:27], v[16:19], v[176:179]
  ds_read_b128 v[68:71], v49 offset:53248
  v_mfma_f32_16x16x32_bf16 v[184:187], v[24:27], v[20:23], v[184:187]
  ds_read_b128 v[72:75], v49 offset:55296
  v_mfma_f32_16x16x32_bf16 v[164:167], v[28:31], v[8:11], v[164:167]
  ds_read_b64_tr_b16 v[76:77], v51 offset:36864
  v_mfma_f32_16x16x32_bf16 v[172:175], v[28:31], v[12:15], v[172:175]
  ds_read_b64_tr_b16 v[78:79], v51 offset:37376
  v_mfma_f32_16x16x32_bf16 v[180:183], v[28:31], v[16:19], v[180:183]
  ds_read_b64_tr_b16 v[80:81], v53 offset:36864
  v_mfma_f32_16x16x32_bf16 v[188:191], v[28:31], v[20:23], v[188:191]
  ds_read_b64_tr_b16 v[82:83], v53 offset:37376
  v_mfma_f32_16x16x32_bf16 v[192:195], v[32:35], v[8:11], v[192:195]
  ds_read_b64_tr_b16 v[84:85], v51 offset:38912
  v_mfma_f32_16x16x32_bf16 v[200:203], v[32:35], v[12:15], v[200:203]
  ds_read_b64_tr_b16 v[86:87], v51 offset:39424
  v_mfma_f32_16x16x32_bf16 v[208:211], v[32:35], v[16:19], v[208:211]
  ds_read_b64_tr_b16 v[88:89], v53 offset:38912
  v_mfma_f32_16x16x32_bf16 v[216:219], v[32:35], v[20:23], v[216:219]
  ds_read_b64_tr_b16 v[90:91], v53 offset:39424
  v_mfma_f32_16x16x32_bf16 v[196:199], v[36:39], v[8:11], v[196:199]
  ds_read_b64_tr_b16 v[92:93], v55 offset:36864
  v_mfma_f32_16x16x32_bf16 v[204:207], v[36:39], v[12:15], v[204:207]
  ds_read_b64_tr_b16 v[94:95], v55 offset:37376
  v_mfma_f32_16x16x32_bf16 v[212:215], v[36:39], v[16:19], v[212:215]
  ds_read_b64_tr_b16 v[96:97], v57 offset:36864
  v_mfma_f32_16x16x32_bf16 v[220:223], v[36:39], v[20:23], v[220:223]
  ds_read_b64_tr_b16 v[98:99], v57 offset:37376
  v_mfma_f32_16x16x32_bf16 v[224:227], v[8:11], v[40:43], v[224:227]
  v_mfma_f32_16x16x32_bf16 v[232:235], v[12:15], v[40:43], v[232:235]
  v_mfma_f32_16x16x32_bf16 v[240:243], v[16:19], v[40:43], v[240:243]
  v_mfma_f32_16x16x32_bf16 v[248:251], v[20:23], v[40:43], v[248:251]
  v_mfma_f32_16x16x32_bf16 v[228:231], v[8:11], v[44:47], v[228:231]
  v_mfma_f32_16x16x32_bf16 v[236:239], v[12:15], v[44:47], v[236:239]
  v_mfma_f32_16x16x32_bf16 v[244:247], v[16:19], v[44:47], v[244:247]
  v_mfma_f32_16x16x32_bf16 v[252:255], v[20:23], v[44:47], v[252:255]
  s_waitcnt lgkmcnt(0)
  s_barrier
  v_mfma_f32_16x16x32_bf16 v[160:163], v[76:79], v[60:63], v[160:163]
  ds_read_b128 v[8:11], v48 offset:0
  v_mfma_f32_16x16x32_bf16 v[168:171], v[76:79], v[64:67], v[168:171]
  ds_read_b128 v[12:15], v48 offset:2048
  v_mfma_f32_16x16x32_bf16 v[176:179], v[76:79], v[68:71], v[176:179]
  ds_read_b128 v[16:19], v48 offset:4096
  v_mfma_f32_16x16x32_bf16 v[184:187], v[76:79], v[72:75], v[184:187]
  ds_read_b128 v[20:23], v48 offset:6144
  v_mfma_f32_16x16x32_bf16 v[164:167], v[80:83], v[60:63], v[164:167]
  ds_read_b64_tr_b16 v[24:25], v50 offset:0
  v_mfma_f32_16x16x32_bf16 v[172:175], v[80:83], v[64:67], v[172:175]
  ds_read_b64_tr_b16 v[26:27], v50 offset:512
  v_mfma_f32_16x16x32_bf16 v[180:183], v[80:83], v[68:71], v[180:183]
  ds_read_b64_tr_b16 v[28:29], v52 offset:0
  v_mfma_f32_16x16x32_bf16 v[188:191], v[80:83], v[72:75], v[188:191]
  ds_read_b64_tr_b16 v[30:31], v52 offset:512
  v_mfma_f32_16x16x32_bf16 v[192:195], v[84:87], v[60:63], v[192:195]
  ds_read_b64_tr_b16 v[32:33], v50 offset:2048
  v_mfma_f32_16x16x32_bf16 v[200:203], v[84:87], v[64:67], v[200:203]
  ds_read_b64_tr_b16 v[34:35], v50 offset:2560
  v_mfma_f32_16x16x32_bf16 v[208:211], v[84:87], v[68:71], v[208:211]
  ds_read_b64_tr_b16 v[36:37], v52 offset:2048
  v_mfma_f32_16x16x32_bf16 v[216:219], v[84:87], v[72:75], v[216:219]
  ds_read_b64_tr_b16 v[38:39], v52 offset:2560
  v_mfma_f32_16x16x32_bf16 v[196:199], v[88:91], v[60:63], v[196:199]
  ds_read_b64_tr_b16 v[40:41], v54 offset:0
  v_mfma_f32_16x16x32_bf16 v[204:207], v[88:91], v[64:67], v[204:207]
  ds_read_b64_tr_b16 v[42:43], v54 offset:512
  v_mfma_f32_16x16x32_bf16 v[212:215], v[88:91], v[68:71], v[212:215]
  ds_read_b64_tr_b16 v[44:45], v56 offset:0
  v_mfma_f32_16x16x32_bf16 v[220:223], v[88:91], v[72:75], v[220:223]
  ds_read_b64_tr_b16 v[46:47], v56 offset:512
  v_mfma_f32_16x16x32_bf16 v[224:227], v[60:63], v[92:95], v[224:227]
  v_mfma_f32_16x16x32_bf16 v[232:235], v[64:67], v[92:95], v[232:235]
  v_mfma_f32_16x16x32_bf16 v[240:243], v[68:71], v[92:95], v[240:243]
  v_mfma_f32_16x16x32_bf16 v[248:251], v[72:75], v[92:95], v[248:251]
  v_mfma_f32_16x16x32_bf16 v[228:231], v[60:63], v[96:99], v[228:231]
  v_mfma_f32_16x16x32_bf16 v[236:239], v[64:67], v[96:99], v[236:239]
  v_mfma_f32_16x16x32_bf16 v[244:247], v[68:71], v[96:99], v[244:247]
  v_mfma_f32_16x16x32_bf16 v[252:255], v[72:75], v[96:99], v[252:255]
  s_waitcnt lgkmcnt(0)
  s_barrier
  buffer_load_dwordx2 v[6:7], off, s[36:39], 0 sc1
  v_mfma_f32_16x16x32_bf16 v[160:163], v[24:27], v[8:11], v[160:163]
  ds_read_b128 v[60:63], v49 offset:0
  v_mfma_f32_16x16x32_bf16 v[168:171], v[24:27], v[12:15], v[168:171]
  ds_read_b128 v[64:67], v49 offset:2048
  v_mfma_f32_16x16x32_bf16 v[176:179], v[24:27], v[16:19], v[176:179]
  ds_read_b128 v[68:71], v49 offset:4096
  v_mfma_f32_16x16x32_bf16 v[184:187], v[24:27], v[20:23], v[184:187]
  ds_read_b128 v[72:75], v49 offset:6144
  v_mfma_f32_16x16x32_bf16 v[164:167], v[28:31], v[8:11], v[164:167]
  ds_read_b64_tr_b16 v[76:77], v50 offset:12288
  v_mfma_f32_16x16x32_bf16 v[172:175], v[28:31], v[12:15], v[172:175]
  ds_read_b64_tr_b16 v[78:79], v50 offset:12800
  v_mfma_f32_16x16x32_bf16 v[180:183], v[28:31], v[16:19], v[180:183]
  ds_read_b64_tr_b16 v[80:81], v52 offset:12288
  v_mfma_f32_16x16x32_bf16 v[188:191], v[28:31], v[20:23], v[188:191]
  ds_read_b64_tr_b16 v[82:83], v52 offset:12800
  v_mfma_f32_16x16x32_bf16 v[192:195], v[32:35], v[8:11], v[192:195]
  ds_read_b64_tr_b16 v[84:85], v50 offset:14336
  v_mfma_f32_16x16x32_bf16 v[200:203], v[32:35], v[12:15], v[200:203]
  ds_read_b64_tr_b16 v[86:87], v50 offset:14848
  v_mfma_f32_16x16x32_bf16 v[208:211], v[32:35], v[16:19], v[208:211]
  ds_read_b64_tr_b16 v[88:89], v52 offset:14336
  v_mfma_f32_16x16x32_bf16 v[216:219], v[32:35], v[20:23], v[216:219]
  ds_read_b64_tr_b16 v[90:91], v52 offset:14848
  v_mfma_f32_16x16x32_bf16 v[196:199], v[36:39], v[8:11], v[196:199]
  ds_read_b64_tr_b16 v[92:93], v54 offset:12288
  v_mfma_f32_16x16x32_bf16 v[204:207], v[36:39], v[12:15], v[204:207]
  ds_read_b64_tr_b16 v[94:95], v54 offset:12800
  v_mfma_f32_16x16x32_bf16 v[212:215], v[36:39], v[16:19], v[212:215]
  ds_read_b64_tr_b16 v[96:97], v56 offset:12288
  v_mfma_f32_16x16x32_bf16 v[220:223], v[36:39], v[20:23], v[220:223]
  ds_read_b64_tr_b16 v[98:99], v56 offset:12800
  v_mfma_f32_16x16x32_bf16 v[224:227], v[8:11], v[40:43], v[224:227]
  v_mfma_f32_16x16x32_bf16 v[232:235], v[12:15], v[40:43], v[232:235]
  v_mfma_f32_16x16x32_bf16 v[240:243], v[16:19], v[40:43], v[240:243]
  v_mfma_f32_16x16x32_bf16 v[248:251], v[20:23], v[40:43], v[248:251]
  v_mfma_f32_16x16x32_bf16 v[228:231], v[8:11], v[44:47], v[228:231]
  v_mfma_f32_16x16x32_bf16 v[236:239], v[12:15], v[44:47], v[236:239]
  v_mfma_f32_16x16x32_bf16 v[244:247], v[16:19], v[44:47], v[244:247]
  v_mfma_f32_16x16x32_bf16 v[252:255], v[20:23], v[44:47], v[252:255]
  s_waitcnt lgkmcnt(0)
  s_barrier
  v_mfma_f32_16x16x32_bf16 v[160:163], v[76:79], v[60:63], v[160:163]
  ds_read_b128 v[8:11], v48 offset:16384
  v_mfma_f32_16x16x32_bf16 v[168:171], v[76:79], v[64:67], v[168:171]
  ds_read_b128 v[12:15], v48 offset:18432
  v_mfma_f32_16x16x32_bf16 v[176:179], v[76:79], v[68:71], v[176:179]
  ds_read_b128 v[16:19], v48 offset:20480
  v_mfma_f32_16x16x32_bf16 v[184:187], v[76:79], v[72:75], v[184:187]
  ds_read_b128 v[20:23], v48 offset:22528
  v_mfma_f32_16x16x32_bf16 v[164:167], v[80:83], v[60:63], v[164:167]
  ds_read_b64_tr_b16 v[24:25], v50 offset:24576
  v_mfma_f32_16x16x32_bf16 v[172:175], v[80:83], v[64:67], v[172:175]
  ds_read_b64_tr_b16 v[26:27], v50 offset:25088
  v_mfma_f32_16x16x32_bf16 v[180:183], v[80:83], v[68:71], v[180:183]
  ds_read_b64_tr_b16 v[28:29], v52 offset:24576
  v_mfma_f32_16x16x32_bf16 v[188:191], v[80:83], v[72:75], v[188:191]
  ds_read_b64_tr_b16 v[30:31], v52 offset:25088
  v_mfma_f32_16x16x32_bf16 v[192:195], v[84:87], v[60:63], v[192:195]
  ds_read_b64_tr_b16 v[32:33], v50 offset:26624
  v_mfma_f32_16x16x32_bf16 v[200:203], v[84:87], v[64:67], v[200:203]
  ds_read_b64_tr_b16 v[34:35], v50 offset:27136
  v_mfma_f32_16x16x32_bf16 v[208:211], v[84:87], v[68:71], v[208:211]
  ds_read_b64_tr_b16 v[36:37], v52 offset:26624
  v_mfma_f32_16x16x32_bf16 v[216:219], v[84:87], v[72:75], v[216:219]
  ds_read_b64_tr_b16 v[38:39], v52 offset:27136
  v_mfma_f32_16x16x32_bf16 v[196:199], v[88:91], v[60:63], v[196:199]
  ds_read_b64_tr_b16 v[40:41], v54 offset:24576
  v_mfma_f32_16x16x32_bf16 v[204:207], v[88:91], v[64:67], v[204:207]
  ds_read_b64_tr_b16 v[42:43], v54 offset:25088
  v_mfma_f32_16x16x32_bf16 v[212:215], v[88:91], v[68:71], v[212:215]
  ds_read_b64_tr_b16 v[44:45], v56 offset:24576
  v_mfma_f32_16x16x32_bf16 v[220:223], v[88:91], v[72:75], v[220:223]
  ds_read_b64_tr_b16 v[46:47], v56 offset:25088
  v_mfma_f32_16x16x32_bf16 v[224:227], v[60:63], v[92:95], v[224:227]
  v_mfma_f32_16x16x32_bf16 v[232:235], v[64:67], v[92:95], v[232:235]
  v_mfma_f32_16x16x32_bf16 v[240:243], v[68:71], v[92:95], v[240:243]
  v_mfma_f32_16x16x32_bf16 v[248:251], v[72:75], v[92:95], v[248:251]
  v_mfma_f32_16x16x32_bf16 v[228:231], v[60:63], v[96:99], v[228:231]
  v_mfma_f32_16x16x32_bf16 v[236:239], v[64:67], v[96:99], v[236:239]
  v_mfma_f32_16x16x32_bf16 v[244:247], v[68:71], v[96:99], v[244:247]
  v_mfma_f32_16x16x32_bf16 v[252:255], v[72:75], v[96:99], v[252:255]
  s_waitcnt lgkmcnt(0)
  s_barrier
  v_mfma_f32_16x16x32_bf16 v[160:163], v[24:27], v[8:11], v[160:163]
  ds_read_b128 v[60:63], v49 offset:16384
  v_mfma_f32_16x16x32_bf16 v[168:171], v[24:27], v[12:15], v[168:171]
  ds_read_b128 v[64:67], v49 offset:18432
  v_mfma_f32_16x16x32_bf16 v[176:179], v[24:27], v[16:19], v[176:179]
  ds_read_b128 v[68:71], v49 offset:20480
  v_mfma_f32_16x16x32_bf16 v[184:187], v[24:27], v[20:23], v[184:187]
  ds_read_b128 v[72:75], v49 offset:22528
  v_mfma_f32_16x16x32_bf16 v[164:167], v[28:31], v[8:11], v[164:167]
  ds_read_b64_tr_b16 v[76:77], v50 offset:36864
  v_mfma_f32_16x16x32_bf16 v[172:175], v[28:31], v[12:15], v[172:175]
  ds_read_b64_tr_b16 v[78:79], v50 offset:37376
  v_mfma_f32_16x16x32_bf16 v[180:183], v[28:31], v[16:19], v[180:183]
  ds_read_b64_tr_b16 v[80:81], v52 offset:36864
  v_mfma_f32_16x16x32_bf16 v[188:191], v[28:31], v[20:23], v[188:191]
  ds_read_b64_tr_b16 v[82:83], v52 offset:37376
  v_mfma_f32_16x16x32_bf16 v[192:195], v[32:35], v[8:11], v[192:195]
  ds_read_b64_tr_b16 v[84:85], v50 offset:38912
  v_mfma_f32_16x16x32_bf16 v[200:203], v[32:35], v[12:15], v[200:203]
  ds_read_b64_tr_b16 v[86:87], v50 offset:39424
  v_mfma_f32_16x16x32_bf16 v[208:211], v[32:35], v[16:19], v[208:211]
  ds_read_b64_tr_b16 v[88:89], v52 offset:38912
  v_mfma_f32_16x16x32_bf16 v[216:219], v[32:35], v[20:23], v[216:219]
  ds_read_b64_tr_b16 v[90:91], v52 offset:39424
  v_mfma_f32_16x16x32_bf16 v[196:199], v[36:39], v[8:11], v[196:199]
  ds_read_b64_tr_b16 v[92:93], v54 offset:36864
  v_mfma_f32_16x16x32_bf16 v[204:207], v[36:39], v[12:15], v[204:207]
  ds_read_b64_tr_b16 v[94:95], v54 offset:37376
  v_mfma_f32_16x16x32_bf16 v[212:215], v[36:39], v[16:19], v[212:215]
  ds_read_b64_tr_b16 v[96:97], v56 offset:36864
  v_mfma_f32_16x16x32_bf16 v[220:223], v[36:39], v[20:23], v[220:223]
  ds_read_b64_tr_b16 v[98:99], v56 offset:37376
  v_mfma_f32_16x16x32_bf16 v[224:227], v[8:11], v[40:43], v[224:227]
  v_mfma_f32_16x16x32_bf16 v[232:235], v[12:15], v[40:43], v[232:235]
  v_mfma_f32_16x16x32_bf16 v[240:243], v[16:19], v[40:43], v[240:243]
  v_mfma_f32_16x16x32_bf16 v[248:251], v[20:23], v[40:43], v[248:251]
  v_mfma_f32_16x16x32_bf16 v[228:231], v[8:11], v[44:47], v[228:231]
  v_mfma_f32_16x16x32_bf16 v[236:239], v[12:15], v[44:47], v[236:239]
  v_mfma_f32_16x16x32_bf16 v[244:247], v[16:19], v[44:47], v[244:247]
  v_mfma_f32_16x16x32_bf16 v[252:255], v[20:23], v[44:47], v[252:255]
  s_waitcnt lgkmcnt(0)
  s_barrier
  v_mfma_f32_16x16x32_bf16 v[160:163], v[76:79], v[60:63], v[160:163]
  ds_read_b128 v[8:11], v48 offset:32768
  v_mfma_f32_16x16x32_bf16 v[168:171], v[76:79], v[64:67], v[168:171]
  ds_read_b128 v[12:15], v48 offset:34816
  v_mfma_f32_16x16x32_bf16 v[176:179], v[76:79], v[68:71], v[176:179]
  ds_read_b128 v[16:19], v48 offset:36864
  v_mfma_f32_16x16x32_bf16 v[184:187], v[76:79], v[72:75], v[184:187]
  ds_read_b128 v[20:23], v48 offset:38912
  v_mfma_f32_16x16x32_bf16 v[164:167], v[80:83], v[60:63], v[164:167]
  ds_read_b64_tr_b16 v[24:25], v51 offset:0
  v_mfma_f32_16x16x32_bf16 v[172:175], v[80:83], v[64:67], v[172:175]
  ds_read_b64_tr_b16 v[26:27], v51 offset:512
  v_mfma_f32_16x16x32_bf16 v[180:183], v[80:83], v[68:71], v[180:183]
  ds_read_b64_tr_b16 v[28:29], v53 offset:0
  v_mfma_f32_16x16x32_bf16 v[188:191], v[80:83], v[72:75], v[188:191]
  ds_read_b64_tr_b16 v[30:31], v53 offset:512
  v_mfma_f32_16x16x32_bf16 v[192:195], v[84:87], v[60:63], v[192:195]
  ds_read_b64_tr_b16 v[32:33], v51 offset:2048
  v_mfma_f32_16x16x32_bf16 v[200:203], v[84:87], v[64:67], v[200:203]
  ds_read_b64_tr_b16 v[34:35], v51 offset:2560
  v_mfma_f32_16x16x32_bf16 v[208:211], v[84:87], v[68:71], v[208:211]
  ds_read_b64_tr_b16 v[36:37], v53 offset:2048
  v_mfma_f32_16x16x32_bf16 v[216:219], v[84:87], v[72:75], v[216:219]
  ds_read_b64_tr_b16 v[38:39], v53 offset:2560
  v_mfma_f32_16x16x32_bf16 v[196:199], v[88:91], v[60:63], v[196:199]
  ds_read_b64_tr_b16 v[40:41], v55 offset:0
  v_mfma_f32_16x16x32_bf16 v[204:207], v[88:91], v[64:67], v[204:207]
  ds_read_b64_tr_b16 v[42:43], v55 offset:512
  v_mfma_f32_16x16x32_bf16 v[212:215], v[88:91], v[68:71], v[212:215]
  ds_read_b64_tr_b16 v[44:45], v57 offset:0
  v_mfma_f32_16x16x32_bf16 v[220:223], v[88:91], v[72:75], v[220:223]
  ds_read_b64_tr_b16 v[46:47], v57 offset:512
  v_mfma_f32_16x16x32_bf16 v[224:227], v[60:63], v[92:95], v[224:227]
  v_mfma_f32_16x16x32_bf16 v[232:235], v[64:67], v[92:95], v[232:235]
  v_mfma_f32_16x16x32_bf16 v[240:243], v[68:71], v[92:95], v[240:243]
  v_mfma_f32_16x16x32_bf16 v[248:251], v[72:75], v[92:95], v[248:251]
  v_mfma_f32_16x16x32_bf16 v[228:231], v[60:63], v[96:99], v[228:231]
  v_mfma_f32_16x16x32_bf16 v[236:239], v[64:67], v[96:99], v[236:239]
  s_cmp_eq_u32 s25, 0
  s_cbranch_scc1 aux_e
  v_and_b32 v5, 15, v0
  v_lshlrev_b32 v5, 10, v5
  buffer_load_dword v125, v5, s[52:55], s43 offen
aux_e:
  v_mfma_f32_16x16x32_bf16 v[244:247], v[68:71], v[96:99], v[244:247]
  v_mfma_f32_16x16x32_bf16 v[252:255], v[72:75], v[96:99], v[252:255]
  s_waitcnt lgkmcnt(0)
  s_barrier
  v_mfma_f32_16x16x32_bf16 v[160:163], v[24:27], v[8:11], v[160:163]
  ds_read_b128 v[60:63], v49 offset:32768
  v_mfma_f32_16x16x32_bf16 v[168:171], v[24:27], v[12:15], v[168:171]
  ds_read_b128 v[64:67], v49 offset:34816
  v_mfma_f32_16x16x32_bf16 v[176:179], v[24:27], v[16:19], v[176:179]
  ds_read_b128 v[68:71], v49 offset:36864
  v_mfma_f32_16x16x32_bf16 v[184:187], v[24:27], v[20:23], v[184:187]
  ds_read_b128 v[72:75], v49 offset:38912
  v_mfma_f32_16x16x32_bf16 v[164:167], v[28:31], v[8:11], v[164:167]
  ds_read_b64_tr_b16 v[76:77], v51 offset:12288
  v_mfma_f32_16x16x32_bf16 v[172:175], v[28:31], v[12:15], v[172:175]
  ds_read_b64_tr_b16 v[78:79], v51 offset:12800
  v_mfma_f32_16x16x32_bf16 v[180:183], v[28:31], v[16:19], v[180:183]
  ds_read_b64_tr_b16 v[80:81], v53 offset:12288
  v_mfma_f32_16x16x32_bf16 v[188:191], v[28:31], v[20:23], v[188:191]
  ds_read_b64_tr_b16 v[82:83], v53 offset:12800
  v_mfma_f32_16x16x32_bf16 v[192:195], v[32:35], v[8:11], v[192:195]
  ds_read_b64_tr_b16 v[84:85], v51 offset:14336
  v_mfma_f32_16x16x32_bf16 v[200:203], v[32:35], v[12:15], v[200:203]
  ds_read_b64_tr_b16 v[86:87], v51 offset:14848
  v_mfma_f32_16x16x32_bf16 v[208:211], v[32:35], v[16:19], v[208:211]
  ds_read_b64_tr_b16 v[88:89], v53 offset:14336
  v_mfma_f32_16x16x32_bf16 v[216:219], v[32:35], v[20:23], v[216:219]
  ds_read_b64_tr_b16 v[90:91], v53 offset:14848
  v_mfma_f32_16x16x32_bf16 v[196:199], v[36:39], v[8:11], v[196:199]
  ds_read_b64_tr_b16 v[92:93], v55 offset:12288
  v_mfma_f32_16x16x32_bf16 v[204:207], v[36:39], v[12:15], v[204:207]
  ds_read_b64_tr_b16 v[94:95], v55 offset:12800
  v_mfma_f32_16x16x32_bf16 v[212:215], v[36:39], v[16:19], v[212:215]
  ds_read_b64_tr_b16 v[96:97], v57 offset:12288
  v_mfma_f32_16x16x32_bf16 v[220:223], v[36:39], v[20:23], v[220:223]
  ds_read_b64_tr_b16 v[98:99], v57 offset:12800
  v_mfma_f32_16x16x32_bf16 v[224:227], v[8:11], v[40:43], v[224:227]
  v_mfma_f32_16x16x32_bf16 v[232:235], v[12:15], v[40:43], v[232:235]
  v_mfma_f32_16x16x32_bf16 v[240:243], v[16:19], v[40:43], v[240:243]
  v_mfma_f32_16x16x32_bf16 v[248:251], v[20:23], v[40:43], v[248:251]
  v_mfma_f32_16x16x32_bf16 v[228:231], v[8:11], v[44:47], v[228:231]
  v_mfma_f32_16x16x32_bf16 v[236:239], v[12:15], v[44:47], v[236:239]
  v_mfma_f32_16x16x32_bf16 v[244:247], v[16:19], v[44:47], v[244:247]
  v_mfma_f32_16x16x32_bf16 v[252:255], v[20:23], v[44:47], v[252:255]
  s_waitcnt lgkmcnt(0)
  s_barrier
  v_mfma_f32_16x16x32_bf16 v[160:163], v[76:79], v[60:63], v[160:163]
  ds_read_b128 v[8:11], v48 offset:49152
  v_mfma_f32_16x16x32_bf16 v[168:171], v[76:79], v[64:67], v[168:171]
  ds_read_b128 v[12:15], v48 offset:51200
  v_mfma_f32_16x16x32_bf16 v[176:179], v[76:79], v[68:71], v[176:179]
  ds_read_b128 v[16:19], v48 offset:53248
  v_mfma_f32_16x16x32_bf16 v[184:187], v[76:79], v[72:75], v[184:187]
  ds_read_b128 v[20:23], v48 offset:55296
  v_mfma_f32_16x16x32_bf16 v[164:167], v[80:83], v[60:63], v[164:167]
  ds_read_b64_tr_b16 v[24:25], v51 offset:24576
  v_mfma_f32_16x16x32_bf16 v[172:175], v[80:83], v[64:67], v[172:175]
  ds_read_b64_tr_b16 v[26:27], v51 offset:25088
  v_mfma_f32_16x16x32_bf16 v[180:183], v[80:83], v[68:71], v[180:183]
  ds_read_b64_tr_b16 v[28:29], v53 offset:24576
  v_mfma_f32_16x16x32_bf16 v[188:191], v[80:83], v[72:75], v[188:191]
  ds_read_b64_tr_b16 v[30:31], v53 offset:25088
  v_mfma_f32_16x16x32_bf16 v[192:195], v[84:87], v[60:63], v[192:195]
  ds_read_b64_tr_b16 v[32:33], v51 offset:26624
  v_mfma_f32_16x16x32_bf16 v[200:203], v[84:87], v[64:67], v[200:203]
  ds_read_b64_tr_b16 v[34:35], v51 offset:27136
  v_mfma_f32_16x16x32_bf16 v[208:211], v[84:87], v[68:71], v[208:211]
  ds_read_b64_tr_b16 v[36:37], v53 offset:26624
  v_mfma_f32_16x16x32_bf16 v[216:219], v[84:87], v[72:75], v[216:219]
  ds_read_b64_tr_b16 v[38:39], v53 offset:27136
  v_mfma_f32_16x16x32_bf16 v[196:199], v[88:91], v[60:63], v[196:199]
  ds_read_b64_tr_b16 v[40:41], v55 offset:24576
  v_mfma_f32_16x16x32_bf16 v[204:207], v[88:91], v[64:67], v[204:207]
  ds_read_b64_tr_b16 v[42:43], v55 offset:25088
  v_mfma_f32_16x16x32_bf16 v[212:215], v[88:91], v[68:71], v[212:215]
  ds_read_b64_tr_b16 v[44:45], v57 offset:24576
  v_mfma_f32_16x16x32_bf16 v[220:223], v[88:91], v[72:75], v[220:223]
  ds_read_b64_tr_b16 v[46:47], v57 offset:25088
  v_mfma_f32_16x16x32_bf16 v[224:227], v[60:63], v[92:95], v[224:227]
  v_mfma_f32_16x16x32_bf16 v[232:235], v[64:67], v[92:95], v[232:235]
  v_mfma_f32_16x16x32_bf16 v[240:243], v[68:71], v[92:95], v[240:243]
  v_mfma_f32_16x16x32_bf16 v[248:251], v[72:75], v[92:95], v[248:251]
  v_mfma_f32_16x16x32_bf16 v[228:231], v[60:63], v[96:99], v[228:231]
  v_mfma_f32_16x16x32_bf16 v[236:239], v[64:67], v[96:99], v[236:239]
  v_mfma_f32_16x16x32_bf16 v[244:247], v[68:71], v[96:99], v[244:247]
  v_mfma_f32_16x16x32_bf16 v[252:255], v[72:75], v[96:99], v[252:255]
  s_waitcnt lgkmcnt(0)
  s_barrier
  v_mfma_f32_16x16x32_bf16 v[160:163], v[24:27], v[8:11], v[160:163]
  ds_read_b128 v[60:63], v49 offset:49152
  v_mfma_f32_16x16x32_bf16 v[168:171], v[24:27], v[12:15], v[168:171]
  ds_read_b128 v[64:67], v49 offset:51200
  v_mfma_f32_16x16x32_bf16 v[176:179], v[24:27], v[16:19], v[176:179]
  ds_read_b128 v[68:71], v49 offset:53248
  v_mfma_f32_16x16x32_bf16 v[184:187], v[24:27], v[20:23], v[184:187]
  ds_read_b128 v[72:75], v49 offset:55296
  v_mfma_f32_16x16x32_bf16 v[164:167], v[28:31], v[8:11], v[164:167]
  ds_read_b64_tr_b16 v[76:77], v51 offset:36864
  v_mfma_f32_16x16x32_bf16 v[172:175], v[28:31], v[12:15], v[172:175]
  ds_read_b64_tr_b16 v[78:79], v51 offset:37376
  v_mfma_f32_16x16x32_bf16 v[180:183], v[28:31], v[16:19], v[180:183]
  ds_read_b64_tr_b16 v[80:81], v53 offset:36864
  v_mfma_f32_16x16x32_bf16 v[188:191], v[28:31], v[20:23], v[188:191]
  ds_read_b64_tr_b16 v[82:83], v53 offset:37376
  v_mfma_f32_16x16x32_bf16 v[192:195], v[32:35], v[8:11], v[192:195]
  ds_read_b64_tr_b16 v[84:85], v51 offset:38912
  v_mfma_f32_16x16x32_bf16 v[200:203], v[32:35], v[12:15], v[200:203]
  ds_read_b64_tr_b16 v[86:87], v51 offset:39424
  v_mfma_f32_16x16x32_bf16 v[208:211], v[32:35], v[16:19], v[208:211]
  ds_read_b64_tr_b16 v[88:89], v53 offset:38912
  v_mfma_f32_16x16x32_bf16 v[216:219], v[32:35], v[20:23], v[216:219]
  ds_read_b64_tr_b16 v[90:91], v53 offset:39424
  v_mfma_f32_16x16x32_bf16 v[196:199], v[36:39], v[8:11], v[196:199]
  ds_read_b64_tr_b16 v[92:93], v55 offset:36864
  v_mfma_f32_16x16x32_bf16 v[204:207], v[36:39], v[12:15], v[204:207]
  ds_read_b64_tr_b16 v[94:95], v55 offset:37376
  v_mfma_f32_16x16x32_bf16 v[212:215], v[36:39], v[16:19], v[212:215]
  ds_read_b64_tr_b16 v[96:97], v57 offset:36864
  v_mfma_f32_16x16x32_bf16 v[220:223], v[36:39], v[20:23], v[220:223]
  ds_read_b64_tr_b16 v[98:99], v57 offset:37376
  v_mfma_f32_16x16x32_bf16 v[224:227], v[8:11], v[40:43], v[224:227]
  v_mfma_f32_16x16x32_bf16 v[232:235], v[12:15], v[40:43], v[232:235]
  v_mfma_f32_16x16x32_bf16 v[240:243], v[16:19], v[40:43], v[240:243]
  v_mfma_f32_16x16x32_bf16 v[248:251], v[20:23], v[40:43], v[248:251]
  v_mfma_f32_16x16x32_bf16 v[228:231], v[8:11], v[44:47], v[228:231]
  v_mfma_f32_16x16x32_bf16 v[236:239], v[12:15], v[44:47], v[236:239]
  v_mfma_f32_16x16x32_bf16 v[244:247], v[16:19], v[44:47], v[244:247]
  v_mfma_f32_16x16x32_bf16 v[252:255], v[20:23], v[44:47], v[252:255]
  s_waitcnt lgkmcnt(0)
  s_barrier
  s_cmp_eq_u32 s25, 0
  s_cbranch_scc1 epi_a
  v_mfma_f32_16x16x32_bf16 v[192:195], v[84:87], v[60:63], v[192:195]
  s_nop 0
  s_nop 0
  v_mfma_f32_16x16x32_bf16 v[196:199], v[88:91], v[60:63], v[196:199]
  s_nop 0
  s_nop 0
  v_mfma_f32_16x16x32_bf16 v[200:203], v[84:87], v[64:67], v[200:203]
  s_nop 0
  s_nop 0
  v_mfma_f32_16x16x32_bf16 v[204:207], v[88:91], v[64:67], v[204:207]
  s_nop 0
  s_nop 0
  v_mfma_f32_16x16x32_bf16 v[224:227], v[60:63], v[92:95], v[224:227]
  v_cvt_pk_bf16_f32 v192, v192, v193
  v_cvt_pk_bf16_f32 v193, v194, v195
  v_mfma_f32_16x16x32_bf16 v[228:231], v[60:63], v[96:99], v[228:231]
  v_cvt_pk_bf16_f32 v194, v196, v197
  v_cvt_pk_bf16_f32 v195, v198, v199
  v_mfma_f32_16x16x32_bf16 v[232:235], v[64:67], v[92:95], v[232:235]
  buffer_store_dwordx4 v[192:195], v59, s[20:23], s41 offen offset:0 sc1
  v_cvt_pk_bf16_f32 v200, v200, v201
  v_mfma_f32_16x16x32_bf16 v[236:239], v[64:67], v[96:99], v[236:239]
  v_cvt_pk_bf16_f32 v201, v202, v203
  v_cvt_pk_bf16_f32 v202, v204, v205
  v_mfma_f32_16x16x32_bf16 v[160:163], v[76:79], v[60:63], v[160:163]
  v_cvt_pk_bf16_f32 v203, v206, v207
  buffer_store_dwordx4 v[200:203], v59, s[20:23], s41 offen offset:256 sc1
  v_mfma_f32_16x16x32_bf16 v[164:167], v[80:83], v[60:63], v[164:167]
  v_cvt_pk_bf16_f32 v224, v224, v225
  v_cvt_pk_bf16_f32 v225, v226, v227
  v_mfma_f32_16x16x32_bf16 v[168:171], v[76:79], v[64:67], v[168:171]
  v_cvt_pk_bf16_f32 v226, v228, v229
  v_cvt_pk_bf16_f32 v227, v230, v231
  v_mfma_f32_16x16x32_bf16 v[172:175], v[80:83], v[64:67], v[172:175]
  v_permlane16_swap_b32 v224, v226
  v_permlane16_swap_b32 v225, v227
  v_mfma_f32_16x16x32_bf16 v[176:179], v[76:79], v[68:71], v[176:179]
  buffer_store_dwordx4 v[224:227], v59, s[20:23], s41 offen offset:1024 sc1
  v_cvt_pk_bf16_f32 v232, v232, v233
  v_mfma_f32_16x16x32_bf16 v[180:183], v[80:83], v[68:71], v[180:183]
  v_cvt_pk_bf16_f32 v233, v234, v235
  v_cvt_pk_bf16_f32 v234, v236, v237
  v_mfma_f32_16x16x32_bf16 v[184:187], v[76:79], v[72:75], v[184:187]
  v_cvt_pk_bf16_f32 v235, v238, v239
  v_permlane16_swap_b32 v232, v234
  v_mfma_f32_16x16x32_bf16 v[188:191], v[80:83], v[72:75], v[188:191]
  v_permlane16_swap_b32 v233, v235
  buffer_store_dwordx4 v[232:235], v59, s[20:23], s41 offen offset:1280 sc1
  v_mfma_f32_16x16x32_bf16 v[208:211], v[84:87], v[68:71], v[208:211]
  v_mul_f32 v160, v116, v160
  v_mul_f32 v161, v116, v161
  v_mfma_f32_16x16x32_bf16 v[212:215], v[88:91], v[68:71], v[212:215]
  v_mul_f32 v162, v116, v162
  v_mul_f32 v163, v116, v163
  v_mfma_f32_16x16x32_bf16 v[240:243], v[68:71], v[92:95], v[240:243]
  v_mul_f32 v164, v116, v164
  v_mul_f32 v165, v116, v165
  v_mfma_f32_16x16x32_bf16 v[244:247], v[68:71], v[96:99], v[244:247]
  v_mul_f32 v166, v116, v166
  v_mul_f32 v167, v116, v167
  v_mfma_f32_16x16x32_bf16 v[216:219], v[84:87], v[72:75], v[216:219]
  v_cvt_pk_bf16_f32 v160, v160, v161
  v_cvt_pk_bf16_f32 v161, v162, v163
  v_mfma_f32_16x16x32_bf16 v[220:223], v[88:91], v[72:75], v[220:223]
  v_cvt_pk_bf16_f32 v162, v164, v165
  v_cvt_pk_bf16_f32 v163, v166, v167
  v_mfma_f32_16x16x32_bf16 v[248:251], v[72:75], v[92:95], v[248:251]
  buffer_store_dwordx4 v[160:163], v58, s[20:23], s40 offen offset:0 sc1
  v_mul_f32 v168, v116, v168
  v_mfma_f32_16x16x32_bf16 v[252:255], v[72:75], v[96:99], v[252:255]
  v_mul_f32 v169, v116, v169
  v_mul_f32 v170, v116, v170
  v_mul_f32 v171, v116, v171
  v_mul_f32 v172, v116, v172
  v_mul_f32 v173, v116, v173
  v_mul_f32 v174, v116, v174
  v_mul_f32 v175, v116, v175
  v_cvt_pk_bf16_f32 v168, v168, v169
  v_cvt_pk_bf16_f32 v169, v170, v171
  v_cvt_pk_bf16_f32 v170, v172, v173
  v_cvt_pk_bf16_f32 v171, v174, v175
  buffer_store_dwordx4 v[168:171], v58, s[20:23], s40 offen offset:256 sc1
  v_mul_f32 v176, v116, v176
  v_mul_f32 v177, v116, v177
  v_mul_f32 v178, v116, v178
  v_mul_f32 v179, v116, v179
  v_mul_f32 v180, v116, v180
  v_mul_f32 v181, v116, v181
  v_mul_f32 v182, v116, v182
  v_mul_f32 v183, v116, v183
  v_cvt_pk_bf16_f32 v176, v176, v177
  v_cvt_pk_bf16_f32 v177, v178, v179
  v_cvt_pk_bf16_f32 v178, v180, v181
  v_cvt_pk_bf16_f32 v179, v182, v183
  buffer_store_dwordx4 v[176:179], v58, s[20:23], s40 offen offset:1024 sc1
  v_mul_f32 v184, v116, v184
  v_mul_f32 v185, v116, v185
  v_mul_f32 v186, v116, v186
  v_mul_f32 v187, v116, v187
  v_mul_f32 v188, v116, v188
  v_mul_f32 v189, v116, v189
  v_mul_f32 v190, v116, v190
  v_mul_f32 v191, v116, v191
  v_cvt_pk_bf16_f32 v184, v184, v185
  v_cvt_pk_bf16_f32 v185, v186, v187
  v_cvt_pk_bf16_f32 v186, v188, v189
  v_cvt_pk_bf16_f32 v187, v190, v191
  buffer_store_dwordx4 v[184:187], v58, s[20:23], s40 offen offset:1280 sc1
  s_mov_b32 m0, s8
  s_add_u32 s3, s43, 7168
  buffer_load_dwordx4 v124, s[52:55], s43 offen lds
  buffer_load_dwordx4 v124, s[52:55], s3 offen offset:1024 lds
  s_lshl_b32 s3, s7, 11
  s_lshl_b32 s31, s6, 6
  s_add_u32 s3, s3, s31
  s_add_u32 s31, s3, 13631488
  s_add_u32 s43, s42, 32768
  v_cvt_pk_bf16_f32 v208, v208, v209
  v_cvt_pk_bf16_f32 v209, v210, v211
  v_cvt_pk_bf16_f32 v210, v212, v213
  v_cvt_pk_bf16_f32 v211, v214, v215
  v_cvt_pk_bf16_f32 v240, v240, v241
  v_cvt_pk_bf16_f32 v241, v242, v243
  v_cvt_pk_bf16_f32 v242, v244, v245
  v_cvt_pk_bf16_f32 v243, v246, v247
  s_nop 0
  v_permlane16_swap_b32 v240, v242
  v_permlane16_swap_b32 v241, v243
  v_cvt_pk_bf16_f32 v216, v216, v217
  v_cvt_pk_bf16_f32 v217, v218, v219
  v_cvt_pk_bf16_f32 v218, v220, v221
  v_cvt_pk_bf16_f32 v219, v222, v223
  v_cvt_pk_bf16_f32 v248, v248, v249
  v_cvt_pk_bf16_f32 v249, v250, v251
  v_cvt_pk_bf16_f32 v250, v252, v253
  v_cvt_pk_bf16_f32 v251, v254, v255
  s_nop 0
  v_permlane16_swap_b32 v248, v250
  v_permlane16_swap_b32 v249, v251
  s_waitcnt vmcnt(10)
  v_readfirstlane_b32 s98, v6
  v_readfirstlane_b32 s99, v7
  s_nop 1
  s_min_u32 s3, s98, s99
  s_cmp_lg_u32 s3, 0
  s_cbranch_scc1 have_tag3
  s_mov_b32 s10, 0x200000
nonce4:
  buffer_load_dwordx2 v[6:7], off, s[36:39], 0 sc1
  s_waitcnt vmcnt(0)
  v_readfirstlane_b32 s98, v6
  v_readfirstlane_b32 s99, v7
  s_nop 1
  s_min_u32 s3, s98, s99
  s_cmp_lg_u32 s3, 0
  s_cbranch_scc1 nonce4_ok
  s_sub_u32 s10, s10, 1
  s_cbranch_scc0 nonce4
nonce4_ok:
have_tag3:
  s_waitcnt vmcnt(2)
  v_mov_b32 v6, s98
  v_mov_b32 v7, s99
  s_mov_b64 exec, 1
  buffer_store_dwordx2 v[6:7], off, s[20:23], s31 sc1
  s_mov_b64 exec, -1
  s_add_u32 s31, s31, 655360
  s_waitcnt vmcnt(1)
  ds_read_b64_tr_b16 v[108:109], v119 offset:0
  ds_read_b64_tr_b16 v[110:111], v119 offset:1024
  ds_read_b64_tr_b16 v[112:113], v119 offset:64
  ds_read_b64_tr_b16 v[114:115], v119 offset:1088
  s_waitcnt lgkmcnt(0)
  v_mov_b32 v84, 0x3f803f80
  v_mov_b32 v85, 0x3f803f80
  v_mov_b64 v[86:87], v[84:85]
  v_mov_b64 v[88:89], v[84:85]
  v_mov_b64 v[90:91], v[84:85]
  v_mov_b64 v[92:93], v[84:85]
  v_mov_b64 v[94:95], v[84:85]
  v_mov_b64 v[96:97], v[84:85]
  v_mov_b64 v[98:99], v[84:85]
  v_mov_b64 v[60:61], 0
  v_mov_b64 v[62:63], 0
  v_mov_b64 v[64:65], 0
  v_mov_b64 v[66:67], 0
  v_mov_b64 v[68:69], 0
  v_mov_b64 v[70:71], 0
  v_mov_b64 v[72:73], 0
  v_mov_b64 v[74:75], 0
  s_lshl_b32 s3, s24, 12
  s_add_u32 s3, s3, 131072
  v_add_u32 v5, s3, v1
  s_barrier
  ds_read_b128 v[8:11], v5
  ds_read_b128 v[76:79], v2
  ds_read_b128 v[80:83], v2 offset:2048
  s_mov_b64 exec, s[32:33]
  ds_read_b128 v[84:87], v2 offset:1024
  ds_read_b128 v[88:91], v2 offset:1280
  s_mov_b64 exec, -1
  buffer_store_dwordx4 v[208:211], v59, s[20:23], s9 offen offset:0 sc1
  buffer_store_dwordx4 v[240:243], v59, s[20:23], s9 offen offset:1024 sc1
  buffer_store_dwordx4 v[216:219], v59, s[20:23], s9 offen offset:256 sc1
  buffer_store_dwordx4 v[248:251], v59, s[20:23], s9 offen offset:1280 sc1
  buffer_store_dwordx4 v[108:111], v1, s[20:23], s42 offen sc1
  buffer_store_dwordx4 v[112:115], v1, s[20:23], s43 offen sc1
  s_branch after_x
epi_a:
  v_mfma_f32_16x16x32_bf16 v[192:195], v[84:87], v[60:63], v[192:195]
  s_nop 0
  s_nop 0
  v_mfma_f32_16x16x32_bf16 v[196:199], v[88:91], v[60:63], v[196:199]
  s_nop 0
  s_nop 0
  v_mfma_f32_16x16x32_bf16 v[200:203], v[84:87], v[64:67], v[200:203]
  s_nop 0
  s_nop 0
  v_mfma_f32_16x16x32_bf16 v[204:207], v[88:91], v[64:67], v[204:207]
  s_nop 0
  s_nop 0
  v_mfma_f32_16x16x32_bf16 v[208:211], v[84:87], v[68:71], v[208:211]
  s_nop 0
  s_nop 0
  v_mfma_f32_16x16x32_bf16 v[212:215], v[88:91], v[68:71], v[212:215]
  s_nop 0
  s_nop 0
  v_mfma_f32_16x16x32_bf16 v[216:219], v[84:87], v[72:75], v[216:219]
  v_cvt_pk_bf16_f32 v192, v192, v193
  v_cvt_pk_bf16_f32 v193, v194, v195
  v_mfma_f32_16x16x32_bf16 v[220:223], v[88:91], v[72:75], v[220:223]
  v_cvt_pk_bf16_f32 v194, v196, v197
  v_cvt_pk_bf16_f32 v195, v198, v199
  v_mfma_f32_16x16x32_bf16 v[224:227], v[60:63], v[92:95], v[224:227]
  v_cvt_pk_bf16_f32 v200, v200, v201
  v_cvt_pk_bf16_f32 v201, v202, v203
  v_mfma_f32_16x16x32_bf16 v[228:231], v[60:63], v[96:99], v[228:231]
  v_cvt_pk_bf16_f32 v202, v204, v205
  v_cvt_pk_bf16_f32 v203, v206, v207
  v_mfma_f32_16x16x32_bf16 v[232:235], v[64:67], v[92:95], v[232:235]
  v_permlane16_swap_b32 v192, v200
  v_permlane16_swap_b32 v193, v201
  v_mfma_f32_16x16x32_bf16 v[236:239], v[64:67], v[96:99], v[236:239]
  v_permlane16_swap_b32 v194, v202
  v_permlane16_swap_b32 v195, v203
  v_mfma_f32_16x16x32_bf16 v[240:243], v[68:71], v[92:95], v[240:243]
  s_nop 0
  v_mfma_f32_32x32x16_bf16 v[8:23], v[100:103], v[192:195], 0
  v_cvt_pk_bf16_f32 v208, v208, v209
  v_mfma_f32_16x16x32_bf16 v[244:247], v[68:71], v[96:99], v[244:247]
  v_cvt_pk_bf16_f32 v209, v210, v211
  v_cvt_pk_bf16_f32 v210, v212, v213
  v_mfma_f32_16x16x32_bf16 v[248:251], v[72:75], v[92:95], v[248:251]
  v_cvt_pk_bf16_f32 v211, v214, v215
  v_cvt_pk_bf16_f32 v216, v216, v217
  v_mfma_f32_16x16x32_bf16 v[252:255], v[72:75], v[96:99], v[252:255]
  v_cvt_pk_bf16_f32 v217, v218, v219
  v_cvt_pk_bf16_f32 v218, v220, v221
  v_mfma_f32_16x16x32_bf16 v[160:163], v[76:79], v[60:63], v[160:163]
  v_cvt_pk_bf16_f32 v219, v222, v223
  v_permlane16_swap_b32 v208, v216
  v_mfma_f32_16x16x32_bf16 v[164:167], v[80:83], v[60:63], v[164:167]
  v_permlane16_swap_b32 v209, v217
  v_permlane16_swap_b32 v210, v218
  v_mfma_f32_16x16x32_bf16 v[168:171], v[76:79], v[64:67], v[168:171]
  v_permlane16_swap_b32 v211, v219
  s_nop 1
  v_mfma_f32_32x32x16_bf16 v[24:39], v[100:103], v[208:211], 0
  v_mfma_f32_16x16x32_bf16 v[172:175], v[80:83], v[64:67], v[172:175]
  v_cvt_pk_bf16_f32 v224, v224, v225
  v_cvt_pk_bf16_f32 v225, v226, v227
  v_mfma_f32_16x16x32_bf16 v[176:179], v[76:79], v[68:71], v[176:179]
  v_cvt_pk_bf16_f32 v226, v228, v229
  v_cvt_pk_bf16_f32 v227, v230, v231
  v_mfma_f32_16x16x32_bf16 v[180:183], v[80:83], v[68:71], v[180:183]
  v_permlane16_swap_b32 v224, v226
  v_permlane16_swap_b32 v225, v227
  v_mfma_f32_16x16x32_bf16 v[184:187], v[76:79], v[72:75], v[184:187]
  v_permlane32_swap_b32 v224, v226
  v_permlane32_swap_b32 v225, v227
  v_mfma_f32_16x16x32_bf16 v[188:191], v[80:83], v[72:75], v[188:191]
  v_cvt_pk_bf16_f32 v232, v232, v233
  v_cvt_pk_bf16_f32 v233, v234, v235
  v_cvt_pk_bf16_f32 v234, v236, v237
  v_cvt_pk_bf16_f32 v235, v238, v239
  s_nop 0
  v_permlane16_swap_b32 v232, v234
  v_permlane16_swap_b32 v233, v235
  s_nop 0
  v_permlane32_swap_b32 v232, v234
  v_permlane32_swap_b32 v233, v235
  v_cvt_pk_bf16_f32 v240, v240, v241
  v_cvt_pk_bf16_f32 v241, v242, v243
  v_cvt_pk_bf16_f32 v242, v244, v245
  v_cvt_pk_bf16_f32 v243, v246, v247
  s_nop 0
  v_permlane16_swap_b32 v240, v242
  v_permlane16_swap_b32 v241, v243
  s_nop 0
  v_permlane32_swap_b32 v240, v242
  v_permlane32_swap_b32 v241, v243
  v_cvt_pk_bf16_f32 v248, v248, v249
  v_cvt_pk_bf16_f32 v249, v250, v251
  v_cvt_pk_bf16_f32 v250, v252, v253
  v_cvt_pk_bf16_f32 v251, v254, v255
  s_nop 0
  v_permlane16_swap_b32 v248, v250
  v_permlane16_swap_b32 v249, v251
  s_nop 0
  v_permlane32_swap_b32 v248, v250
  v_permlane32_swap_b32 v249, v251
  v_cvt_pk_bf16_f32 v160, v160, v161
  v_cvt_pk_bf16_f32 v161, v162, v163
  v_cvt_pk_bf16_f32 v162, v164, v165
  v_cvt_pk_bf16_f32 v163, v166, v167
  v_cvt_pk_bf16_f32 v168, v168, v169
  v_cvt_pk_bf16_f32 v169, v170, v171
  v_cvt_pk_bf16_f32 v170, v172, v173
  v_cvt_pk_bf16_f32 v171, v174, v175
  v_permlane16_swap_b32 v160, v168
  v_permlane16_swap_b32 v161, v169
  v_permlane16_swap_b32 v162, v170
  v_permlane16_swap_b32 v163, v171
  v_cvt_pk_bf16_f32 v176, v176, v177
  v_cvt_pk_bf16_f32 v177, v178, v179
  v_cvt_pk_bf16_f32 v178, v180, v181
  v_cvt_pk_bf16_f32 v179, v182, v183
  v_cvt_pk_bf16_f32 v184, v184, v185
  v_cvt_pk_bf16_f32 v185, v186, v187
  v_cvt_pk_bf16_f32 v186, v188, v189
  v_cvt_pk_bf16_f32 v187, v190, v191
  v_permlane16_swap_b32 v176, v184
  v_permlane16_swap_b32 v177, v185
  v_permlane16_swap_b32 v178, v186
  v_permlane16_swap_b32 v179, v187
  v_mfma_f32_32x32x16_bf16 v[40:55], v[104:107], v[200:203], 0
  v_mfma_f32_32x32x16_bf16 v[56:71], v[104:107], v[216:219], 0
  v_bfi_b32 v228, v117, v224, v118
  v_bfi_b32 v229, v117, v225, v118
  v_bfi_b32 v230, v117, v226, v118
  v_bfi_b32 v231, v117, v227, v118
  v_bfi_b32 v236, v117, v232, v118
  v_bfi_b32 v237, v117, v233, v118
  v_bfi_b32 v238, v117, v234, v118
  v_bfi_b32 v239, v117, v235, v118
  v_bfi_b32 v244, v117, v240, v118
  v_bfi_b32 v245, v117, v241, v118
  v_bfi_b32 v246, v117, v242, v118
  v_bfi_b32 v247, v117, v243, v118
  v_bfi_b32 v252, v117, v248, v118
  v_bfi_b32 v253, v117, v249, v118
  v_bfi_b32 v254, v117, v250, v118
  v_bfi_b32 v255, v117, v251, v118
  v_max3_f32 v120, v8, v9, v10
  v_max3_f32 v122, v24, v25, v26
  v_max3_f32 v121, v11, v12, v13
  v_max3_f32 v123, v27, v28, v29
  v_max3_f32 v120, v120, v14, v15
  v_max3_f32 v122, v122, v30, v31
  v_max3_f32 v121, v121, v16, v17
  v_max3_f32 v123, v123, v32, v33
  v_max3_f32 v120, v120, v18, v19
  v_max3_f32 v122, v122, v34, v35
  v_max3_f32 v121, v121, v20, v21
  v_max3_f32 v123, v123, v36, v37
  v_max3_f32 v120, v120, v22, v23
  v_max3_f32 v122, v122, v38, v39
  v_max_f32 v120, v120, v121
  v_max_f32 v122, v122, v123
  v_mul_f32 v120, v116, v120
  v_mul_f32 v122, v116, v122
  v_pk_fma_f32 v[8:9], v[8:9], v[116:117], v[120:121] op_sel_hi:[1,0,0] neg_lo:[0,0,1] neg_hi:[0,0,1]
  v_pk_fma_f32 v[24:25], v[24:25], v[116:117], v[122:123] op_sel_hi:[1,0,0] neg_lo:[0,0,1] neg_hi:[0,0,1]
  v_pk_fma_f32 v[10:11], v[10:11], v[116:117], v[120:121] op_sel_hi:[1,0,0] neg_lo:[0,0,1] neg_hi:[0,0,1]
  v_pk_fma_f32 v[26:27], v[26:27], v[116:117], v[122:123] op_sel_hi:[1,0,0] neg_lo:[0,0,1] neg_hi:[0,0,1]
  v_pk_fma_f32 v[12:13], v[12:13], v[116:117], v[120:121] op_sel_hi:[1,0,0] neg_lo:[0,0,1] neg_hi:[0,0,1]
  v_pk_fma_f32 v[28:29], v[28:29], v[116:117], v[122:123] op_sel_hi:[1,0,0] neg_lo:[0,0,1] neg_hi:[0,0,1]
  v_pk_fma_f32 v[14:15], v[14:15], v[116:117], v[120:121] op_sel_hi:[1,0,0] neg_lo:[0,0,1] neg_hi:[0,0,1]
  v_pk_fma_f32 v[30:31], v[30:31], v[116:117], v[122:123] op_sel_hi:[1,0,0] neg_lo:[0,0,1] neg_hi:[0,0,1]
  v_pk_fma_f32 v[16:17], v[16:17], v[116:117], v[120:121] op_sel_hi:[1,0,0] neg_lo:[0,0,1] neg_hi:[0,0,1]
  v_pk_fma_f32 v[32:33], v[32:33], v[116:117], v[122:123] op_sel_hi:[1,0,0] neg_lo:[0,0,1] neg_hi:[0,0,1]
  v_pk_fma_f32 v[18:19], v[18:19], v[116:117], v[120:121] op_sel_hi:[1,0,0] neg_lo:[0,0,1] neg_hi:[0,0,1]
  v_pk_fma_f32 v[34:35], v[34:35], v[116:117], v[122:123] op_sel_hi:[1,0,0] neg_lo:[0,0,1] neg_hi:[0,0,1]
  v_pk_fma_f32 v[20:21], v[20:21], v[116:117], v[120:121] op_sel_hi:[1,0,0] neg_lo:[0,0,1] neg_hi:[0,0,1]
  v_pk_fma_f32 v[36:37], v[36:37], v[116:117], v[122:123] op_sel_hi:[1,0,0] neg_lo:[0,0,1] neg_hi:[0,0,1]
  v_pk_fma_f32 v[22:23], v[22:23], v[116:117], v[120:121] op_sel_hi:[1,0,0] neg_lo:[0,0,1] neg_hi:[0,0,1]
  v_pk_fma_f32 v[38:39], v[38:39], v[116:117], v[122:123] op_sel_hi:[1,0,0] neg_lo:[0,0,1] neg_hi:[0,0,1]
  v_exp_f32 v8, v8
  v_exp_f32 v24, v24
  v_exp_f32 v9, v9
  v_exp_f32 v25, v25
  v_exp_f32 v10, v10
  v_exp_f32 v26, v26
  v_exp_f32 v11, v11
  v_exp_f32 v27, v27
  v_exp_f32 v12, v12
  v_exp_f32 v28, v28
  v_exp_f32 v13, v13
  v_exp_f32 v29, v29
  v_exp_f32 v14, v14
  v_exp_f32 v30, v30
  v_exp_f32 v15, v15
  v_exp_f32 v31, v31
  v_exp_f32 v16, v16
  v_exp_f32 v32, v32
  v_exp_f32 v17, v17
  v_exp_f32 v33, v33
  v_exp_f32 v18, v18
  v_exp_f32 v34, v34
  v_exp_f32 v19, v19
  v_exp_f32 v35, v35
  v_exp_f32 v20, v20
  v_exp_f32 v36, v36
  v_exp_f32 v21, v21
  v_exp_f32 v37, v37
  v_exp_f32 v22, v22
  v_exp_f32 v38, v38
  v_exp_f32 v23, v23
  v_exp_f32 v39, v39
  v_pk_add_f32 v[72:73], v[8:9], v[10:11]
  v_pk_add_f32 v[80:81], v[24:25], v[26:27]
  v_pk_add_f32 v[74:75], v[12:13], v[14:15]
  v_pk_add_f32 v[82:83], v[28:29], v[30:31]
  v_pk_add_f32 v[76:77], v[16:17], v[18:19]
  v_pk_add_f32 v[84:85], v[32:33], v[34:35]
  v_pk_add_f32 v[78:79], v[20:21], v[22:23]
  v_pk_add_f32 v[86:87], v[36:37], v[38:39]
  v_pk_add_f32 v[72:73], v[72:73], v[74:75]
  v_pk_add_f32 v[80:81], v[80:81], v[82:83]
  v_pk_add_f32 v[76:77], v[76:77], v[78:79]
  v_pk_add_f32 v[84:85], v[84:85], v[86:87]
  v_pk_add_f32 v[72:73], v[72:73], v[76:77]
  v_pk_add_f32 v[80:81], v[80:81], v[84:85]
  v_add_f32 v120, v72, v73
  v_add_f32 v122, v80, v81
  v_rcp_f32 v120, v120
  v_rcp_f32 v122, v122
  v_pk_mul_f32 v[8:9], v[8:9], v[120:121] op_sel_hi:[1,0]
  v_pk_mul_f32 v[24:25], v[24:25], v[122:123] op_sel_hi:[1,0]
  v_pk_mul_f32 v[10:11], v[10:11], v[120:121] op_sel_hi:[1,0]
  v_pk_mul_f32 v[26:27], v[26:27], v[122:123] op_sel_hi:[1,0]
  v_pk_mul_f32 v[12:13], v[12:13], v[120:121] op_sel_hi:[1,0]
  v_pk_mul_f32 v[28:29], v[28:29], v[122:123] op_sel_hi:[1,0]
  v_pk_mul_f32 v[14:15], v[14:15], v[120:121] op_sel_hi:[1,0]
  v_pk_mul_f32 v[30:31], v[30:31], v[122:123] op_sel_hi:[1,0]
  v_pk_mul_f32 v[16:17], v[16:17], v[120:121] op_sel_hi:[1,0]
  v_pk_mul_f32 v[32:33], v[32:33], v[122:123] op_sel_hi:[1,0]
  v_pk_mul_f32 v[18:19], v[18:19], v[120:121] op_sel_hi:[1,0]
  v_pk_mul_f32 v[34:35], v[34:35], v[122:123] op_sel_hi:[1,0]
  v_pk_mul_f32 v[20:21], v[20:21], v[120:121] op_sel_hi:[1,0]
  v_pk_mul_f32 v[36:37], v[36:37], v[122:123] op_sel_hi:[1,0]
  v_pk_mul_f32 v[22:23], v[22:23], v[120:121] op_sel_hi:[1,0]
  v_pk_mul_f32 v[38:39], v[38:39], v[122:123] op_sel_hi:[1,0]
  v_cvt_pk_bf16_f32 v192, v8, v9
  v_cvt_pk_bf16_f32 v208, v24, v25
  v_cvt_pk_bf16_f32 v193, v10, v11
  v_cvt_pk_bf16_f32 v209, v26, v27
  v_cvt_pk_bf16_f32 v194, v12, v13
  v_cvt_pk_bf16_f32 v210, v28, v29
  v_cvt_pk_bf16_f32 v195, v14, v15
  v_cvt_pk_bf16_f32 v211, v30, v31
  v_cvt_pk_bf16_f32 v196, v16, v17
  v_cvt_pk_bf16_f32 v212, v32, v33
  v_cvt_pk_bf16_f32 v197, v18, v19
  v_cvt_pk_bf16_f32 v213, v34, v35
  v_cvt_pk_bf16_f32 v198, v20, v21
  v_cvt_pk_bf16_f32 v214, v36, v37
  v_cvt_pk_bf16_f32 v199, v22, v23
  v_cvt_pk_bf16_f32 v215, v38, v39
  v_max3_f32 v120, v40, v41, v42
  v_max3_f32 v122, v56, v57, v58
  v_max3_f32 v121, v43, v44, v45
  v_max3_f32 v123, v59, v60, v61
  v_max3_f32 v120, v120, v46, v47
  v_max3_f32 v122, v122, v62, v63
  v_max3_f32 v121, v121, v48, v49
  v_max3_f32 v123, v123, v64, v65
  v_max3_f32 v120, v120, v50, v51
  v_max3_f32 v122, v122, v66, v67
  v_max3_f32 v121, v121, v52, v53
  v_max3_f32 v123, v123, v68, v69
  v_max3_f32 v120, v120, v54, v55
  v_max3_f32 v122, v122, v70, v71
  v_max_f32 v120, v120, v121
  v_max_f32 v122, v122, v123
  v_mul_f32 v120, v116, v120
  v_mul_f32 v122, v116, v122
  v_pk_fma_f32 v[40:41], v[40:41], v[116:117], v[120:121] op_sel_hi:[1,0,0] neg_lo:[0,0,1] neg_hi:[0,0,1]
  v_pk_fma_f32 v[56:57], v[56:57], v[116:117], v[122:123] op_sel_hi:[1,0,0] neg_lo:[0,0,1] neg_hi:[0,0,1]
  v_pk_fma_f32 v[42:43], v[42:43], v[116:117], v[120:121] op_sel_hi:[1,0,0] neg_lo:[0,0,1] neg_hi:[0,0,1]
  v_pk_fma_f32 v[58:59], v[58:59], v[116:117], v[122:123] op_sel_hi:[1,0,0] neg_lo:[0,0,1] neg_hi:[0,0,1]
  v_pk_fma_f32 v[44:45], v[44:45], v[116:117], v[120:121] op_sel_hi:[1,0,0] neg_lo:[0,0,1] neg_hi:[0,0,1]
  v_pk_fma_f32 v[60:61], v[60:61], v[116:117], v[122:123] op_sel_hi:[1,0,0] neg_lo:[0,0,1] neg_hi:[0,0,1]
  v_pk_fma_f32 v[46:47], v[46:47], v[116:117], v[120:121] op_sel_hi:[1,0,0] neg_lo:[0,0,1] neg_hi:[0,0,1]
  v_pk_fma_f32 v[62:63], v[62:63], v[116:117], v[122:123] op_sel_hi:[1,0,0] neg_lo:[0,0,1] neg_hi:[0,0,1]
  v_pk_fma_f32 v[48:49], v[48:49], v[116:117], v[120:121] op_sel_hi:[1,0,0] neg_lo:[0,0,1] neg_hi:[0,0,1]
  v_pk_fma_f32 v[64:65], v[64:65], v[116:117], v[122:123] op_sel_hi:[1,0,0] neg_lo:[0,0,1] neg_hi:[0,0,1]
  v_pk_fma_f32 v[50:51], v[50:51], v[116:117], v[120:121] op_sel_hi:[1,0,0] neg_lo:[0,0,1] neg_hi:[0,0,1]
  v_pk_fma_f32 v[66:67], v[66:67], v[116:117], v[122:123] op_sel_hi:[1,0,0] neg_lo:[0,0,1] neg_hi:[0,0,1]
  v_pk_fma_f32 v[52:53], v[52:53], v[116:117], v[120:121] op_sel_hi:[1,0,0] neg_lo:[0,0,1] neg_hi:[0,0,1]
  v_pk_fma_f32 v[68:69], v[68:69], v[116:117], v[122:123] op_sel_hi:[1,0,0] neg_lo:[0,0,1] neg_hi:[0,0,1]
  v_pk_fma_f32 v[54:55], v[54:55], v[116:117], v[120:121] op_sel_hi:[1,0,0] neg_lo:[0,0,1] neg_hi:[0,0,1]
  v_pk_fma_f32 v[70:71], v[70:71], v[116:117], v[122:123] op_sel_hi:[1,0,0] neg_lo:[0,0,1] neg_hi:[0,0,1]
  v_mfma_f32_32x32x16_bf16 v[8:23], v[192:195], v[108:111], 0
  v_exp_f32 v40, v40
  v_exp_f32 v56, v56
  v_exp_f32 v41, v41
  v_mfma_f32_32x32x16_bf16 v[24:39], v[208:211], v[108:111], 0
  v_exp_f32 v57, v57
  v_exp_f32 v42, v42
  v_exp_f32 v58, v58
  v_mfma_f32_32x32x16_bf16 v[8:23], v[196:199], v[112:115], v[8:23]
  v_exp_f32 v43, v43
  v_exp_f32 v59, v59
  v_exp_f32 v44, v44
  v_mfma_f32_32x32x16_bf16 v[24:39], v[212:215], v[112:115], v[24:39]
  v_exp_f32 v60, v60
  v_exp_f32 v45, v45
  v_exp_f32 v61, v61
  v_exp_f32 v46, v46
  v_exp_f32 v62, v62
  v_exp_f32 v47, v47
  v_exp_f32 v63, v63
  v_exp_f32 v48, v48
  v_exp_f32 v64, v64
  v_exp_f32 v49, v49
  v_exp_f32 v65, v65
  v_exp_f32 v50, v50
  v_exp_f32 v66, v66
  v_exp_f32 v51, v51
  v_exp_f32 v67, v67
  v_exp_f32 v52, v52
  v_exp_f32 v68, v68
  v_exp_f32 v53, v53
  v_exp_f32 v69, v69
  v_exp_f32 v54, v54
  v_exp_f32 v70, v70
  v_exp_f32 v55, v55
  v_exp_f32 v71, v71
  v_pk_add_f32 v[72:73], v[40:41], v[42:43]
  v_pk_add_f32 v[80:81], v[56:57], v[58:59]
  v_pk_add_f32 v[74:75], v[44:45], v[46:47]
  v_pk_add_f32 v[82:83], v[60:61], v[62:63]
  v_pk_add_f32 v[76:77], v[48:49], v[50:51]
  v_pk_add_f32 v[84:85], v[64:65], v[66:67]
  v_pk_add_f32 v[78:79], v[52:53], v[54:55]
  v_pk_add_f32 v[86:87], v[68:69], v[70:71]
  v_pk_add_f32 v[72:73], v[72:73], v[74:75]
  v_pk_add_f32 v[80:81], v[80:81], v[82:83]
  v_pk_add_f32 v[76:77], v[76:77], v[78:79]
  v_pk_add_f32 v[84:85], v[84:85], v[86:87]
  v_pk_add_f32 v[72:73], v[72:73], v[76:77]
  v_pk_add_f32 v[80:81], v[80:81], v[84:85]
  v_add_f32 v120, v72, v73
  v_add_f32 v122, v80, v81
  v_rcp_f32 v120, v120
  v_rcp_f32 v122, v122
  v_pk_mul_f32 v[40:41], v[40:41], v[120:121] op_sel_hi:[1,0]
  v_pk_mul_f32 v[56:57], v[56:57], v[122:123] op_sel_hi:[1,0]
  v_pk_mul_f32 v[42:43], v[42:43], v[120:121] op_sel_hi:[1,0]
  v_pk_mul_f32 v[58:59], v[58:59], v[122:123] op_sel_hi:[1,0]
  v_pk_mul_f32 v[44:45], v[44:45], v[120:121] op_sel_hi:[1,0]
  v_pk_mul_f32 v[60:61], v[60:61], v[122:123] op_sel_hi:[1,0]
  v_pk_mul_f32 v[46:47], v[46:47], v[120:121] op_sel_hi:[1,0]
  v_pk_mul_f32 v[62:63], v[62:63], v[122:123] op_sel_hi:[1,0]
  v_pk_mul_f32 v[48:49], v[48:49], v[120:121] op_sel_hi:[1,0]
  v_pk_mul_f32 v[64:65], v[64:65], v[122:123] op_sel_hi:[1,0]
  v_pk_mul_f32 v[50:51], v[50:51], v[120:121] op_sel_hi:[1,0]
  v_pk_mul_f32 v[66:67], v[66:67], v[122:123] op_sel_hi:[1,0]
  v_pk_mul_f32 v[52:53], v[52:53], v[120:121] op_sel_hi:[1,0]
  v_pk_mul_f32 v[68:69], v[68:69], v[122:123] op_sel_hi:[1,0]
  v_pk_mul_f32 v[54:55], v[54:55], v[120:121] op_sel_hi:[1,0]
  v_pk_mul_f32 v[70:71], v[70:71], v[122:123] op_sel_hi:[1,0]
  v_cvt_pk_bf16_f32 v200, v40, v41
  v_cvt_pk_bf16_f32 v216, v56, v57
  v_cvt_pk_bf16_f32 v201, v42, v43
  v_cvt_pk_bf16_f32 v217, v58, v59
  v_cvt_pk_bf16_f32 v202, v44, v45
  v_cvt_pk_bf16_f32 v218, v60, v61
  v_cvt_pk_bf16_f32 v203, v46, v47
  v_cvt_pk_bf16_f32 v219, v62, v63
  v_cvt_pk_bf16_f32 v204, v48, v49
  v_cvt_pk_bf16_f32 v220, v64, v65
  v_cvt_pk_bf16_f32 v205, v50, v51
  v_cvt_pk_bf16_f32 v221, v66, v67
  v_cvt_pk_bf16_f32 v206, v52, v53
  v_cvt_pk_bf16_f32 v222, v68, v69
  v_cvt_pk_bf16_f32 v207, v54, v55
  v_cvt_pk_bf16_f32 v223, v70, v71
  v_cvt_pk_bf16_f32 v192, v8, v9
  v_cvt_pk_bf16_f32 v193, v10, v11
  v_cvt_pk_bf16_f32 v194, v12, v13
  v_cvt_pk_bf16_f32 v195, v14, v15
  v_cvt_pk_bf16_f32 v196, v16, v17
  v_cvt_pk_bf16_f32 v197, v18, v19
  v_cvt_pk_bf16_f32 v198, v20, v21
  v_cvt_pk_bf16_f32 v199, v22, v23
  v_cvt_pk_bf16_f32 v208, v24, v25
  v_cvt_pk_bf16_f32 v209, v26, v27
  v_cvt_pk_bf16_f32 v210, v28, v29
  v_cvt_pk_bf16_f32 v211, v30, v31
  v_cvt_pk_bf16_f32 v212, v32, v33
  v_cvt_pk_bf16_f32 v213, v34, v35
  v_cvt_pk_bf16_f32 v214, v36, v37
  v_cvt_pk_bf16_f32 v215, v38, v39
  v_mfma_f32_32x32x16_bf16 v[8:23], v[100:103], v[160:163], 0
  v_mfma_f32_32x32x16_bf16 v[24:39], v[100:103], v[176:179], 0
  s_lshl_b32 s3, s24, 13
  s_add_u32 s3, s3, 132096
  v_add_u32 v126, s3, v1
  s_xor_b32 s3, s24, 1
  s_lshl_b32 s3, s3, 13
  s_add_u32 s3, s3, 132096
  v_add_u32 v124, s3, v1
  s_nop 3
  v_max3_f32 v120, v8, v9, v10
  v_max3_f32 v122, v24, v25, v26
  v_max3_f32 v121, v11, v12, v13
  v_max3_f32 v123, v27, v28, v29
  v_max3_f32 v120, v120, v14, v15
  v_max3_f32 v122, v122, v30, v31
  v_max3_f32 v121, v121, v16, v17
  v_max3_f32 v123, v123, v32, v33
  v_max3_f32 v120, v120, v18, v19
  v_max3_f32 v122, v122, v34, v35
  v_max3_f32 v121, v121, v20, v21
  v_max3_f32 v123, v123, v36, v37
  v_max3_f32 v120, v120, v22, v23
  v_max3_f32 v122, v122, v38, v39
  v_max_f32 v120, v120, v121
  v_max_f32 v122, v122, v123
  v_mul_f32 v120, v116, v120
  v_mul_f32 v122, v116, v122
  v_pk_fma_f32 v[8:9], v[8:9], v[116:117], v[120:121] op_sel_hi:[1,0,0] neg_lo:[0,0,1] neg_hi:[0,0,1]
  v_pk_fma_f32 v[24:25], v[24:25], v[116:117], v[122:123] op_sel_hi:[1,0,0] neg_lo:[0,0,1] neg_hi:[0,0,1]
  v_pk_fma_f32 v[10:11], v[10:11], v[116:117], v[120:121] op_sel_hi:[1,0,0] neg_lo:[0,0,1] neg_hi:[0,0,1]
  v_pk_fma_f32 v[26:27], v[26:27], v[116:117], v[122:123] op_sel_hi:[1,0,0] neg_lo:[0,0,1] neg_hi:[0,0,1]
  v_pk_fma_f32 v[12:13], v[12:13], v[116:117], v[120:121] op_sel_hi:[1,0,0] neg_lo:[0,0,1] neg_hi:[0,0,1]
  v_pk_fma_f32 v[28:29], v[28:29], v[116:117], v[122:123] op_sel_hi:[1,0,0] neg_lo:[0,0,1] neg_hi:[0,0,1]
  v_pk_fma_f32 v[14:15], v[14:15], v[116:117], v[120:121] op_sel_hi:[1,0,0] neg_lo:[0,0,1] neg_hi:[0,0,1]
  v_pk_fma_f32 v[30:31], v[30:31], v[116:117], v[122:123] op_sel_hi:[1,0,0] neg_lo:[0,0,1] neg_hi:[0,0,1]
  v_pk_fma_f32 v[16:17], v[16:17], v[116:117], v[120:121] op_sel_hi:[1,0,0] neg_lo:[0,0,1] neg_hi:[0,0,1]
  v_pk_fma_f32 v[32:33], v[32:33], v[116:117], v[122:123] op_sel_hi:[1,0,0] neg_lo:[0,0,1] neg_hi:[0,0,1]
  v_pk_fma_f32 v[18:19], v[18:19], v[116:117], v[120:121] op_sel_hi:[1,0,0] neg_lo:[0,0,1] neg_hi:[0,0,1]
  v_pk_fma_f32 v[34:35], v[34:35], v[116:117], v[122:123] op_sel_hi:[1,0,0] neg_lo:[0,0,1] neg_hi:[0,0,1]
  v_pk_fma_f32 v[20:21], v[20:21], v[116:117], v[120:121] op_sel_hi:[1,0,0] neg_lo:[0,0,1] neg_hi:[0,0,1]
  v_pk_fma_f32 v[36:37], v[36:37], v[116:117], v[122:123] op_sel_hi:[1,0,0] neg_lo:[0,0,1] neg_hi:[0,0,1]
  v_pk_fma_f32 v[22:23], v[22:23], v[116:117], v[120:121] op_sel_hi:[1,0,0] neg_lo:[0,0,1] neg_hi:[0,0,1]
  v_pk_fma_f32 v[38:39], v[38:39], v[116:117], v[122:123] op_sel_hi:[1,0,0] neg_lo:[0,0,1] neg_hi:[0,0,1]
  v_mfma_f32_32x32x16_bf16 v[40:55], v[200:203], v[108:111], 0
  v_exp_f32 v8, v8
  v_exp_f32 v24, v24
  v_exp_f32 v9, v9
  v_mfma_f32_32x32x16_bf16 v[56:71], v[216:219], v[108:111], 0
  v_exp_f32 v25, v25
  v_exp_f32 v10, v10
  v_exp_f32 v26, v26
  v_mfma_f32_32x32x16_bf16 v[40:55], v[204:207], v[112:115], v[40:55]
  v_exp_f32 v11, v11
  v_exp_f32 v27, v27
  v_exp_f32 v12, v12
  v_mfma_f32_32x32x16_bf16 v[56:71], v[220:223], v[112:115], v[56:71]
  v_exp_f32 v28, v28
  v_exp_f32 v13, v13
  v_exp_f32 v29, v29
  v_mfma_f32_32x32x16_bf16 v[128:143], v[192:195], v[228:231], 0
  v_exp_f32 v14, v14
  v_exp_f32 v30, v30
  v_exp_f32 v15, v15
  v_mfma_f32_32x32x16_bf16 v[128:143], v[196:199], v[236:239], v[128:143]
  v_exp_f32 v31, v31
  v_exp_f32 v16, v16
  v_exp_f32 v32, v32
  v_mfma_f32_32x32x16_bf16 v[128:143], v[208:211], v[244:247], v[128:143]
  v_exp_f32 v17, v17
  v_exp_f32 v33, v33
  v_exp_f32 v18, v18
  v_mfma_f32_32x32x16_bf16 v[128:143], v[212:215], v[252:255], v[128:143]
  v_exp_f32 v34, v34
  v_exp_f32 v19, v19
  v_exp_f32 v35, v35
  v_exp_f32 v20, v20
  v_exp_f32 v36, v36
  v_exp_f32 v21, v21
  v_exp_f32 v37, v37
  v_exp_f32 v22, v22
  v_exp_f32 v38, v38
  v_exp_f32 v23, v23
  v_exp_f32 v39, v39
  v_pk_add_f32 v[72:73], v[8:9], v[10:11]
  v_pk_add_f32 v[80:81], v[24:25], v[26:27]
  v_pk_add_f32 v[74:75], v[12:13], v[14:15]
  v_pk_add_f32 v[82:83], v[28:29], v[30:31]
  v_pk_add_f32 v[76:77], v[16:17], v[18:19]
  v_pk_add_f32 v[84:85], v[32:33], v[34:35]
  v_pk_add_f32 v[78:79], v[20:21], v[22:23]
  v_pk_add_f32 v[86:87], v[36:37], v[38:39]
  v_pk_add_f32 v[72:73], v[72:73], v[74:75]
  v_pk_add_f32 v[80:81], v[80:81], v[82:83]
  v_pk_add_f32 v[76:77], v[76:77], v[78:79]
  v_pk_add_f32 v[84:85], v[84:85], v[86:87]
  v_pk_add_f32 v[72:73], v[72:73], v[76:77]
  v_pk_add_f32 v[80:81], v[80:81], v[84:85]
  v_add_f32 v120, v72, v73
  v_add_f32 v122, v80, v81
  v_rcp_f32 v120, v120
  v_rcp_f32 v122, v122
  v_pk_mul_f32 v[8:9], v[8:9], v[120:121] op_sel_hi:[1,0]
  v_pk_mul_f32 v[24:25], v[24:25], v[122:123] op_sel_hi:[1,0]
  v_pk_mul_f32 v[10:11], v[10:11], v[120:121] op_sel_hi:[1,0]
  v_pk_mul_f32 v[26:27], v[26:27], v[122:123] op_sel_hi:[1,0]
  v_pk_mul_f32 v[12:13], v[12:13], v[120:121] op_sel_hi:[1,0]
  v_pk_mul_f32 v[28:29], v[28:29], v[122:123] op_sel_hi:[1,0]
  v_pk_mul_f32 v[14:15], v[14:15], v[120:121] op_sel_hi:[1,0]
  v_pk_mul_f32 v[30:31], v[30:31], v[122:123] op_sel_hi:[1,0]
  v_pk_mul_f32 v[16:17], v[16:17], v[120:121] op_sel_hi:[1,0]
  v_pk_mul_f32 v[32:33], v[32:33], v[122:123] op_sel_hi:[1,0]
  v_pk_mul_f32 v[18:19], v[18:19], v[120:121] op_sel_hi:[1,0]
  v_pk_mul_f32 v[34:35], v[34:35], v[122:123] op_sel_hi:[1,0]
  v_pk_mul_f32 v[20:21], v[20:21], v[120:121] op_sel_hi:[1,0]
  v_pk_mul_f32 v[36:37], v[36:37], v[122:123] op_sel_hi:[1,0]
  v_pk_mul_f32 v[22:23], v[22:23], v[120:121] op_sel_hi:[1,0]
  v_pk_mul_f32 v[38:39], v[38:39], v[122:123] op_sel_hi:[1,0]
  v_cvt_pk_bf16_f32 v160, v8, v9
  v_cvt_pk_bf16_f32 v176, v24, v25
  v_cvt_pk_bf16_f32 v161, v10, v11
  v_cvt_pk_bf16_f32 v177, v26, v27
  v_cvt_pk_bf16_f32 v162, v12, v13
  v_cvt_pk_bf16_f32 v178, v28, v29
  v_cvt_pk_bf16_f32 v163, v14, v15
  v_cvt_pk_bf16_f32 v179, v30, v31
  v_cvt_pk_bf16_f32 v164, v16, v17
  v_cvt_pk_bf16_f32 v180, v32, v33
  v_cvt_pk_bf16_f32 v165, v18, v19
  v_cvt_pk_bf16_f32 v181, v34, v35
  v_cvt_pk_bf16_f32 v166, v20, v21
  v_cvt_pk_bf16_f32 v182, v36, v37
  v_cvt_pk_bf16_f32 v167, v22, v23
  v_cvt_pk_bf16_f32 v183, v38, v39
  v_cvt_pk_bf16_f32 v200, v40, v41
  v_cvt_pk_bf16_f32 v201, v42, v43
  v_cvt_pk_bf16_f32 v202, v44, v45
  v_cvt_pk_bf16_f32 v203, v46, v47
  v_cvt_pk_bf16_f32 v204, v48, v49
  v_cvt_pk_bf16_f32 v205, v50, v51
  v_cvt_pk_bf16_f32 v206, v52, v53
  v_cvt_pk_bf16_f32 v207, v54, v55
  v_cvt_pk_bf16_f32 v216, v56, v57
  v_cvt_pk_bf16_f32 v217, v58, v59
  v_cvt_pk_bf16_f32 v218, v60, v61
  v_cvt_pk_bf16_f32 v219, v62, v63
  v_cvt_pk_bf16_f32 v220, v64, v65
  v_cvt_pk_bf16_f32 v221, v66, v67
  v_cvt_pk_bf16_f32 v222, v68, v69
  v_cvt_pk_bf16_f32 v223, v70, v71
  v_mfma_f32_32x32x16_bf16 v[40:55], v[104:107], v[168:171], 0
  v_mfma_f32_32x32x16_bf16 v[56:71], v[104:107], v[184:187], 0
  v_bfi_b32 v228, v117, v118, v224
  v_bfi_b32 v229, v117, v118, v225
  v_bfi_b32 v230, v117, v118, v226
  v_bfi_b32 v231, v117, v118, v227
  v_bfi_b32 v236, v117, v118, v232
  v_bfi_b32 v237, v117, v118, v233
  v_bfi_b32 v238, v117, v118, v234
  v_bfi_b32 v239, v117, v118, v235
  v_bfi_b32 v244, v117, v118, v240
  v_bfi_b32 v245, v117, v118, v241
  v_bfi_b32 v246, v117, v118, v242
  v_bfi_b32 v247, v117, v118, v243
  v_bfi_b32 v252, v117, v118, v248
  v_bfi_b32 v253, v117, v118, v249
  v_bfi_b32 v254, v117, v118, v250
  v_bfi_b32 v255, v117, v118, v251
  v_max3_f32 v120, v40, v41, v42
  v_max3_f32 v122, v56, v57, v58
  v_max3_f32 v121, v43, v44, v45
  v_max3_f32 v123, v59, v60, v61
  v_max3_f32 v120, v120, v46, v47
  v_max3_f32 v122, v122, v62, v63
  v_max3_f32 v121, v121, v48, v49
  v_max3_f32 v123, v123, v64, v65
  v_max3_f32 v120, v120, v50, v51
  v_max3_f32 v122, v122, v66, v67
  v_max3_f32 v121, v121, v52, v53
  v_max3_f32 v123, v123, v68, v69
  v_max3_f32 v120, v120, v54, v55
  v_max3_f32 v122, v122, v70, v71
  v_max_f32 v120, v120, v121
  v_max_f32 v122, v122, v123
  v_mul_f32 v120, v116, v120
  v_mul_f32 v122, v116, v122
  v_pk_fma_f32 v[40:41], v[40:41], v[116:117], v[120:121] op_sel_hi:[1,0,0] neg_lo:[0,0,1] neg_hi:[0,0,1]
  v_pk_fma_f32 v[56:57], v[56:57], v[116:117], v[122:123] op_sel_hi:[1,0,0] neg_lo:[0,0,1] neg_hi:[0,0,1]
  v_pk_fma_f32 v[42:43], v[42:43], v[116:117], v[120:121] op_sel_hi:[1,0,0] neg_lo:[0,0,1] neg_hi:[0,0,1]
  v_pk_fma_f32 v[58:59], v[58:59], v[116:117], v[122:123] op_sel_hi:[1,0,0] neg_lo:[0,0,1] neg_hi:[0,0,1]
  v_pk_fma_f32 v[44:45], v[44:45], v[116:117], v[120:121] op_sel_hi:[1,0,0] neg_lo:[0,0,1] neg_hi:[0,0,1]
  v_pk_fma_f32 v[60:61], v[60:61], v[116:117], v[122:123] op_sel_hi:[1,0,0] neg_lo:[0,0,1] neg_hi:[0,0,1]
  v_pk_fma_f32 v[46:47], v[46:47], v[116:117], v[120:121] op_sel_hi:[1,0,0] neg_lo:[0,0,1] neg_hi:[0,0,1]
  v_pk_fma_f32 v[62:63], v[62:63], v[116:117], v[122:123] op_sel_hi:[1,0,0] neg_lo:[0,0,1] neg_hi:[0,0,1]
  v_pk_fma_f32 v[48:49], v[48:49], v[116:117], v[120:121] op_sel_hi:[1,0,0] neg_lo:[0,0,1] neg_hi:[0,0,1]
  v_pk_fma_f32 v[64:65], v[64:65], v[116:117], v[122:123] op_sel_hi:[1,0,0] neg_lo:[0,0,1] neg_hi:[0,0,1]
  v_pk_fma_f32 v[50:51], v[50:51], v[116:117], v[120:121] op_sel_hi:[1,0,0] neg_lo:[0,0,1] neg_hi:[0,0,1]
  v_pk_fma_f32 v[66:67], v[66:67], v[116:117], v[122:123] op_sel_hi:[1,0,0] neg_lo:[0,0,1] neg_hi:[0,0,1]
  v_pk_fma_f32 v[52:53], v[52:53], v[116:117], v[120:121] op_sel_hi:[1,0,0] neg_lo:[0,0,1] neg_hi:[0,0,1]
  v_pk_fma_f32 v[68:69], v[68:69], v[116:117], v[122:123] op_sel_hi:[1,0,0] neg_lo:[0,0,1] neg_hi:[0,0,1]
  v_pk_fma_f32 v[54:55], v[54:55], v[116:117], v[120:121] op_sel_hi:[1,0,0] neg_lo:[0,0,1] neg_hi:[0,0,1]
  v_pk_fma_f32 v[70:71], v[70:71], v[116:117], v[122:123] op_sel_hi:[1,0,0] neg_lo:[0,0,1] neg_hi:[0,0,1]
  v_mfma_f32_32x32x16_bf16 v[144:159], v[200:203], v[228:231], 0
  v_exp_f32 v40, v40
  v_exp_f32 v56, v56
  v_exp_f32 v41, v41
  v_mfma_f32_32x32x16_bf16 v[144:159], v[204:207], v[236:239], v[144:159]
  v_exp_f32 v57, v57
  v_exp_f32 v42, v42
  v_exp_f32 v58, v58
  v_mfma_f32_32x32x16_bf16 v[144:159], v[216:219], v[244:247], v[144:159]
  v_exp_f32 v43, v43
  v_exp_f32 v59, v59
  v_exp_f32 v44, v44
  v_mfma_f32_32x32x16_bf16 v[144:159], v[220:223], v[252:255], v[144:159]
  v_exp_f32 v60, v60
  v_exp_f32 v45, v45
  v_exp_f32 v61, v61
  v_exp_f32 v46, v46
  v_exp_f32 v62, v62
  v_exp_f32 v47, v47
  v_exp_f32 v63, v63
  v_exp_f32 v48, v48
  v_exp_f32 v64, v64
  v_exp_f32 v49, v49
  v_exp_f32 v65, v65
  v_exp_f32 v50, v50
  v_exp_f32 v66, v66
  v_exp_f32 v51, v51
  v_exp_f32 v67, v67
  v_exp_f32 v52, v52
  v_exp_f32 v68, v68
  v_exp_f32 v53, v53
  v_exp_f32 v69, v69
  v_exp_f32 v54, v54
  v_exp_f32 v70, v70
  v_exp_f32 v55, v55
  v_exp_f32 v71, v71
  s_cmp_eq_u32 s4, 0
  s_cbranch_scc1 kv_give1
  ds_write_b128 v126, v[128:131] offset:0
  ds_write_b128 v126, v[132:135] offset:1024
  ds_write_b128 v126, v[136:139] offset:4096
  ds_write_b128 v126, v[140:143] offset:5120
  s_branch kv_given
kv_give1:
  ds_write_b128 v126, v[144:147] offset:0
  ds_write_b128 v126, v[148:151] offset:1024
  ds_write_b128 v126, v[152:155] offset:4096
  ds_write_b128 v126, v[156:159] offset:5120
kv_given:
  v_pk_add_f32 v[72:73], v[40:41], v[42:43]
  v_pk_add_f32 v[80:81], v[56:57], v[58:59]
  v_pk_add_f32 v[74:75], v[44:45], v[46:47]
  v_pk_add_f32 v[82:83], v[60:61], v[62:63]
  v_pk_add_f32 v[76:77], v[48:49], v[50:51]
  v_pk_add_f32 v[84:85], v[64:65], v[66:67]
  v_pk_add_f32 v[78:79], v[52:53], v[54:55]
  v_pk_add_f32 v[86:87], v[68:69], v[70:71]
  v_pk_add_f32 v[72:73], v[72:73], v[74:75]
  v_pk_add_f32 v[80:81], v[80:81], v[82:83]
  v_pk_add_f32 v[76:77], v[76:77], v[78:79]
  v_pk_add_f32 v[84:85], v[84:85], v[86:87]
  v_pk_add_f32 v[72:73], v[72:73], v[76:77]
  v_pk_add_f32 v[80:81], v[80:81], v[84:85]
  v_add_f32 v120, v72, v73
  v_add_f32 v122, v80, v81
  v_rcp_f32 v120, v120
  v_rcp_f32 v122, v122
  s_waitcnt lgkmcnt(0)
  s_setprio 3
  s_barrier
  ds_read_b128 v[192:195], v124 offset:0
  ds_read_b128 v[196:199], v124 offset:1024
  ds_read_b128 v[200:203], v124 offset:4096
  ds_read_b128 v[204:207], v124 offset:5120
  v_pk_mul_f32 v[40:41], v[40:41], v[120:121] op_sel_hi:[1,0]
  v_pk_mul_f32 v[56:57], v[56:57], v[122:123] op_sel_hi:[1,0]
  v_pk_mul_f32 v[42:43], v[42:43], v[120:121] op_sel_hi:[1,0]
  v_pk_mul_f32 v[58:59], v[58:59], v[122:123] op_sel_hi:[1,0]
  v_pk_mul_f32 v[44:45], v[44:45], v[120:121] op_sel_hi:[1,0]
  v_pk_mul_f32 v[60:61], v[60:61], v[122:123] op_sel_hi:[1,0]
  v_pk_mul_f32 v[46:47], v[46:47], v[120:121] op_sel_hi:[1,0]
  v_pk_mul_f32 v[62:63], v[62:63], v[122:123] op_sel_hi:[1,0]
  v_pk_mul_f32 v[48:49], v[48:49], v[120:121] op_sel_hi:[1,0]
  v_pk_mul_f32 v[64:65], v[64:65], v[122:123] op_sel_hi:[1,0]
  v_pk_mul_f32 v[50:51], v[50:51], v[120:121] op_sel_hi:[1,0]
  v_pk_mul_f32 v[66:67], v[66:67], v[122:123] op_sel_hi:[1,0]
  v_pk_mul_f32 v[52:53], v[52:53], v[120:121] op_sel_hi:[1,0]
  v_pk_mul_f32 v[68:69], v[68:69], v[122:123] op_sel_hi:[1,0]
  v_pk_mul_f32 v[54:55], v[54:55], v[120:121] op_sel_hi:[1,0]
  v_pk_mul_f32 v[70:71], v[70:71], v[122:123] op_sel_hi:[1,0]
  v_cvt_pk_bf16_f32 v168, v40, v41
  v_cvt_pk_bf16_f32 v184, v56, v57
  v_cvt_pk_bf16_f32 v169, v42, v43
  v_cvt_pk_bf16_f32 v185, v58, v59
  v_cvt_pk_bf16_f32 v170, v44, v45
  v_cvt_pk_bf16_f32 v186, v60, v61
  v_cvt_pk_bf16_f32 v171, v46, v47
  v_cvt_pk_bf16_f32 v187, v62, v63
  v_cvt_pk_bf16_f32 v172, v48, v49
  v_cvt_pk_bf16_f32 v188, v64, v65
  v_cvt_pk_bf16_f32 v173, v50, v51
  v_cvt_pk_bf16_f32 v189, v66, v67
  v_cvt_pk_bf16_f32 v174, v52, v53
  v_cvt_pk_bf16_f32 v190, v68, v69
  v_cvt_pk_bf16_f32 v175, v54, v55
  v_cvt_pk_bf16_f32 v191, v70, v71
  v_mov_b32 v84, 0x3f803f80
  v_mov_b32 v85, 0x3f803f80
  v_mov_b64 v[86:87], v[84:85]
  v_mov_b64 v[88:89], v[84:85]
  v_mov_b64 v[90:91], v[84:85]
  v_mov_b64 v[92:93], v[84:85]
  v_mov_b64 v[94:95], v[84:85]
  v_mov_b64 v[96:97], v[84:85]
  v_mov_b64 v[98:99], v[84:85]
  v_mov_b64 v[60:61], 0
  v_mov_b64 v[62:63], 0
  v_mov_b64 v[64:65], 0
  v_mov_b64 v[66:67], 0
  v_mov_b64 v[68:69], 0
  v_mov_b64 v[70:71], 0
  v_mov_b64 v[72:73], 0
  v_mov_b64 v[74:75], 0
  s_lshl_b32 s3, s24, 12
  s_add_u32 s3, s3, 131072
  v_add_u32 v5, s3, v1
  s_waitcnt vmcnt(0)
  v_readfirstlane_b32 s98, v6
  v_readfirstlane_b32 s99, v7
  s_nop 1
  s_min_u32 s3, s98, s99
  s_cmp_lg_u32 s3, 0
  s_cbranch_scc1 have_tag5
  s_mov_b32 s10, 0x200000
nonce6:
  buffer_load_dwordx2 v[6:7], off, s[36:39], 0 sc1
  s_waitcnt vmcnt(0)
  v_readfirstlane_b32 s98, v6
  v_readfirstlane_b32 s99, v7
  s_nop 1
  s_min_u32 s3, s98, s99
  s_cmp_lg_u32 s3, 0
  s_cbranch_scc1 nonce6_ok
  s_sub_u32 s10, s10, 1
  s_cbranch_scc0 nonce6
nonce6_ok:
have_tag5:
  s_waitcnt lgkmcnt(0)
  ds_read_b128 v[8:11], v5
  ds_read_b128 v[76:79], v2
  ds_read_b128 v[80:83], v2 offset:2048
  s_mov_b64 exec, s[32:33]
  ds_read_b128 v[84:87], v2 offset:1024
  ds_read_b128 v[88:91], v2 offset:1280
  s_mov_b64 exec, -1
  s_cmp_eq_u32 s4, 0
  s_cbranch_scc1 kv_add0
  v_pk_add_f32 v[192:193], v[192:193], v[144:145]
  v_pk_add_f32 v[194:195], v[194:195], v[146:147]
  v_pk_add_f32 v[196:197], v[196:197], v[148:149]
  v_pk_add_f32 v[198:199], v[198:199], v[150:151]
  v_pk_add_f32 v[200:201], v[200:201], v[152:153]
  v_pk_add_f32 v[202:203], v[202:203], v[154:155]
  v_pk_add_f32 v[204:205], v[204:205], v[156:157]
  v_pk_add_f32 v[206:207], v[206:207], v[158:159]
  s_branch kv_added
kv_add0:
  v_pk_add_f32 v[192:193], v[192:193], v[128:129]
  v_pk_add_f32 v[194:195], v[194:195], v[130:131]
  v_pk_add_f32 v[196:197], v[196:197], v[132:133]
  v_pk_add_f32 v[198:199], v[198:199], v[134:135]
  v_pk_add_f32 v[200:201], v[200:201], v[136:137]
  v_pk_add_f32 v[202:203], v[202:203], v[138:139]
  v_pk_add_f32 v[204:205], v[204:205], v[140:141]
  v_pk_add_f32 v[206:207], v[206:207], v[142:143]
kv_added:
  s_add_u32 s3, s7, s4
  s_lshl_b32 s3, s3, 4
  s_add_u32 s3, s3, s26
  s_lshl_b32 s31, s3, 7
  s_add_u32 s31, s31, 13697024
  s_lshl_b32 s3, s3, 12
  s_add_u32 s30, s3, 10485760
  buffer_store_dwordx4 v[192:195], v1, s[20:23], s30 offen offset:0 sc1
  buffer_store_dwordx4 v[196:199], v1, s[20:23], s30 offen offset:1024 sc1
  buffer_store_dwordx4 v[200:203], v1, s[20:23], s30 offen offset:2048 sc1
  buffer_store_dwordx4 v[204:207], v1, s[20:23], s30 offen offset:3072 sc1
after_x:
  ds_read_b128 v[104:107], v2 offset:4096
  ds_read_b128 v[120:123], v2 offset:6144
  s_waitcnt lgkmcnt(4)
  v_mfma_f32_32x32x16_bf16 v[28:43], v[76:79], v[8:11], 0
  v_mfma_f32_32x32x16_bf16 v[44:59], v[80:83], v[8:11], 0
  s_waitcnt lgkmcnt(0)
  v_mfma_f32_32x32x16_bf16 v[12:27], v[104:107], v[8:11], 0
  s_lshr_b32 s43, s24, 2
  s_xor_b32 s18, s43, 1
  s_or_b32 s3, s43, s25
  s_xor_b32 s8, s3, 1
  s_andn2_b32 s17, s43, s25
  s_and_b32 s48, s43, s25
  s_and_b32 s15, s18, s25
  s_cmp_eq_u32 s24, 0
  s_cselect_b32 s9, s25, 0
  v_and_b32 v126, 3, v0
  v_lshlrev_b32 v126, 3, v126
  v_add_u32 v126, 162816, v126
  v_max3_f32 v100, v28, v29, v30
  v_max3_f32 v101, v31, v32, v33
  v_max3_f32 v100, v100, v34, v35
  v_max3_f32 v101, v101, v36, v37
  v_max3_f32 v100, v100, v38, v39
  v_max3_f32 v101, v101, v40, v41
  v_max3_f32 v100, v100, v42, v43
  v_mfma_f32_32x32x16_bf16 v[28:43], v[120:123], v[8:11], 0
  v_max3_f32 v101, v101, v44, v45
  v_max3_f32 v100, v100, v46, v47
  v_max3_f32 v101, v101, v48, v49
  v_max3_f32 v100, v100, v50, v51
  v_max3_f32 v101, v101, v52, v53
  v_max3_f32 v100, v100, v54, v55
  v_max3_f32 v101, v101, v56, v57
  v_max3_f32 v100, v100, v58, v59
  v_max3_f32 v101, v101, v12, v13
  v_max3_f32 v100, v100, v14, v15
  v_max3_f32 v101, v101, v16, v17
  v_max3_f32 v100, v100, v18, v19
  v_max3_f32 v101, v101, v20, v21
  v_max3_f32 v100, v100, v22, v23
  v_max3_f32 v101, v101, v24, v25
  v_max3_f32 v100, v100, v26, v27
  v_max3_f32 v101, v101, v28, v29
  v_max3_f32 v100, v100, v30, v31
  v_max3_f32 v101, v101, v32, v33
  v_max3_f32 v100, v100, v34, v35
  v_max3_f32 v101, v101, v36, v37
  v_max3_f32 v100, v100, v38, v39
  v_max3_f32 v101, v101, v40, v41
  v_max3_f32 v100, v100, v42, v43
  v_max_f32 v100, v100, v101
  v_add_f32 v100, 0x42c80000, v100
attn_restart:
  v_mov_b32 v101, v100
  s_nop 1
  v_permlane32_swap_b32 v100, v101
  v_max_f32 v100, v100, v101
  v_sub_f32 v12, 0, v100
  v_sub_f32 v13, 0, v100
  v_mov_b64 v[14:15], v[12:13]
  v_mov_b64 v[16:17], v[12:13]
  v_mov_b64 v[18:19], v[12:13]
  v_mov_b64 v[20:21], v[12:13]
  v_mov_b64 v[22:23], v[12:13]
  v_mov_b64 v[24:25], v[12:13]
  v_mov_b64 v[26:27], v[12:13]
  s_nop 1
  v_mfma_f32_32x32x16_bf16 v[28:43], v[76:79], v[8:11], v[12:27]
  s_nop 7
  s_setprio 0
  s_cmp_gt_u32 s43, s100
  s_cbranch_scc0 skip7
  s_setprio 1
skip7:
  s_cmp_gt_u32 s17, s100
  s_cbranch_scc0 skip8
  s_waitcnt vmcnt(0)
  s_lshl_b32 s3, s24, 3
  v_mov_b32 v5, s3
  v_add_u32 v5, 162784, v5
  v_mov_b32 v6, s98
  v_mov_b32 v7, s99
  ds_write_b64 v5, v[6:7] offset:64
skip8:
  s_cmp_gt_u32 s43, s100
  s_cbranch_scc0 skip9
  s_waitcnt vmcnt(0)
  v_cmp_ne_u64 vcc, s[98:99], v[102:103]
  s_nop 3
  s_cbranch_vccz seen10
  s_and_b32 s3, s24, 3
  s_lshl_b32 s3, s3, 1
  v_and_b32 v5, 1, v0
  v_bfe_u32 v6, v0, 1, 2
  v_lshl_add_u32 v5, v6, 3, v5
  v_add_u32 v5, s3, v5
  v_lshlrev_b32 v5, 7, v5
  s_mov_b32 s10, 0x200000
poll11:
  buffer_load_dwordx2 v[6:7], v5, s[20:23], s7 offen sc1
  s_waitcnt vmcnt(0)
  v_cmp_ne_u64 vcc, s[98:99], v[6:7]
  s_nop 3
  s_cbranch_vccz poll11_ok
  s_sub_u32 s10, s10, 1
  s_cbranch_scc0 poll11
poll11_ok:
seen10:
  s_add_u32 s7, s7, 655360
skip9:
  s_cmp_gt_u32 s48, s100
  s_cbranch_scc0 skip12
  s_add_u32 m0, s5, 16384
  s_add_u32 s3, m0, s4
  s_and_b32 s3, s3, 0x1ffff
  buffer_load_dwordx4 v1, s[44:47], s3 offen offset:0 sc1 lds
  buffer_load_dwordx4 v1, s[44:47], s3 offen offset:1024 sc1 lds
  buffer_load_dwordx4 v1, s[44:47], s3 offen offset:2048 sc1 lds
  buffer_load_dwordx4 v1, s[44:47], s3 offen offset:3072 sc1 lds
skip12:
  s_waitcnt lgkmcnt(0)
  v_exp_f32 v28, v28
  v_exp_f32 v29, v29
  s_mov_b64 exec, s[32:33]
  ds_read_b128 v[92:95], v2 offset:3072
  ds_read_b128 v[96:99], v2 offset:3328
  s_mov_b64 exec, -1
  v_exp_f32 v30, v30
  v_exp_f32 v31, v31
  v_exp_f32 v32, v32
  v_exp_f32 v33, v33
  v_mfma_f32_32x32x16_bf16 v[44:59], v[80:83], v[8:11], v[12:27]
  ds_read_b128 v[76:79], v2 offset:4096
  v_exp_f32 v34, v34
  v_exp_f32 v35, v35
  v_exp_f32 v36, v36
  v_exp_f32 v37, v37
  v_exp_f32 v38, v38
  v_smfmac_f32_32x32x32_bf16 v[60:75], v[84:87], v[28:35], v3
  v_exp_f32 v39, v39
  v_exp_f32 v40, v40
  v_exp_f32 v41, v41
  v_exp_f32 v42, v42
  v_exp_f32 v43, v43
  s_cmp_gt_u32 s43, s100
  s_cbranch_scc0 skip13
  s_add_u32 m0, s5, 32768
  s_add_u32 s3, m0, s4
  s_and_b32 s3, s3, 0x1ffff
  buffer_load_dwordx4 v1, s[44:47], s3 offen offset:0 sc1 lds
  buffer_load_dwordx4 v1, s[44:47], s3 offen offset:1024 sc1 lds
  buffer_load_dwordx4 v1, s[44:47], s3 offen offset:2048 sc1 lds
  buffer_load_dwordx4 v1, s[44:47], s3 offen offset:3072 sc1 lds
skip13:
  s_waitcnt lgkmcnt(0)
  v_exp_f32 v44, v44
  v_exp_f32 v45, v45
  v_smfmac_f32_32x32x32_bf16 v[60:75], v[88:91], v[36:43], v3
  s_mov_b64 exec, s[32:33]
  ds_read_b128 v[84:87], v2 offset:5120
  ds_read_b128 v[88:91], v2 offset:5376
  s_mov_b64 exec, -1
  v_exp_f32 v46, v46
  v_exp_f32 v47, v47
  v_exp_f32 v48, v48
  v_exp_f32 v49, v49
  v_mfma_f32_32x32x16_bf16 v[28:43], v[76:79], v[8:11], v[12:27]
  ds_read_b128 v[80:83], v2 offset:6144
  v_exp_f32 v50, v50
  v_exp_f32 v51, v51
  v_exp_f32 v52, v52
  v_exp_f32 v53, v53
  v_exp_f32 v54, v54
  v_smfmac_f32_32x32x32_bf16 v[60:75], v[92:95], v[44:51], v3
  v_exp_f32 v55, v55
  v_exp_f32 v56, v56
  v_exp_f32 v57, v57
  v_exp_f32 v58, v58
  v_exp_f32 v59, v59
  s_cmp_gt_u32 s18, s100
  s_cbranch_scc0 skip14
  s_setprio 2
skip14:
  s_cmp_gt_u32 s43, s100
  s_cbranch_scc0 skip15
  s_add_u32 m0, s5, 49152
  s_add_u32 s3, m0, s4
  s_and_b32 s3, s3, 0x1ffff
  buffer_load_dwordx4 v1, s[44:47], s3 offen offset:0 sc1 lds
  buffer_load_dwordx4 v1, s[44:47], s3 offen offset:1024 sc1 lds
  buffer_load_dwordx4 v1, s[44:47], s3 offen offset:2048 sc1 lds
  buffer_load_dwordx4 v1, s[44:47], s3 offen offset:3072 sc1 lds
skip15:
  s_waitcnt lgkmcnt(0)
  v_exp_f32 v28, v28
  v_exp_f32 v29, v29
  v_smfmac_f32_32x32x32_bf16 v[60:75], v[96:99], v[52:59], v3
  s_mov_b64 exec, s[32:33]
  ds_read_b128 v[92:95], v2 offset:7168
  ds_read_b128 v[96:99], v2 offset:7424
  s_mov_b64 exec, -1
  v_exp_f32 v30, v30
  v_exp_f32 v31, v31
  v_exp_f32 v32, v32
  v_exp_f32 v33, v33
  v_mfma_f32_32x32x16_bf16 v[44:59], v[80:83], v[8:11], v[12:27]
  ds_read_b128 v[76:79], v2 offset:8192
  v_exp_f32 v34, v34
  v_exp_f32 v35, v35
  v_exp_f32 v36, v36
  v_exp_f32 v37, v37
  v_exp_f32 v38, v38
  v_smfmac_f32_32x32x32_bf16 v[60:75], v[84:87], v[28:35], v3
  v_exp_f32 v39, v39
  v_exp_f32 v40, v40
  v_exp_f32 v41, v41
  v_exp_f32 v42, v42
  v_exp_f32 v43, v43
  s_cmp_gt_u32 s48, s100
  s_cbranch_scc0 skip16
  s_waitcnt vmcnt(8)
  s_lshl_b32 s3, s24, 3
  v_mov_b32 v5, s3
  v_add_u32 v5, 162784, v5
  v_mov_b32 v6, s98
  v_mov_b32 v7, s99
  ds_write_b64 v5, v[6:7] offset:64
skip16:
  s_waitcnt lgkmcnt(0)
  v_exp_f32 v44, v44
  v_exp_f32 v45, v45
  v_smfmac_f32_32x32x32_bf16 v[60:75], v[88:91], v[36:43], v3
  s_mov_b64 exec, s[32:33]
  ds_read_b128 v[84:87], v2 offset:9216
  ds_read_b128 v[88:91], v2 offset:9472
  s_mov_b64 exec, -1
  v_exp_f32 v46, v46
  v_exp_f32 v47, v47
  v_exp_f32 v48, v48
  v_exp_f32 v49, v49
  v_mfma_f32_32x32x16_bf16 v[28:43], v[76:79], v[8:11], v[12:27]
  ds_read_b128 v[80:83], v2 offset:10240
  v_exp_f32 v50, v50
  v_exp_f32 v51, v51
  v_exp_f32 v52, v52
  v_exp_f32 v53, v53
  v_exp_f32 v54, v54
  v_smfmac_f32_32x32x32_bf16 v[60:75], v[92:95], v[44:51], v3
  v_exp_f32 v55, v55
  v_exp_f32 v56, v56
  v_exp_f32 v57, v57
  v_exp_f32 v58, v58
  v_exp_f32 v59, v59
  s_cmp_gt_u32 s18, s100
  s_cbranch_scc0 skip17
  s_waitcnt vmcnt(0)
  v_mov_b32 v6, s98
  v_mov_b32 v7, s99
  s_mov_b64 exec, 1
  buffer_store_dwordx2 v[6:7], off, s[20:23], s31 sc1
  s_mov_b64 exec, -1
skip17:
  s_waitcnt lgkmcnt(0)
  v_exp_f32 v28, v28
  v_exp_f32 v29, v29
  v_smfmac_f32_32x32x32_bf16 v[60:75], v[96:99], v[52:59], v3
  s_mov_b64 exec, s[32:33]
  ds_read_b128 v[92:95], v2 offset:11264
  ds_read_b128 v[96:99], v2 offset:11520
  s_mov_b64 exec, -1
  v_exp_f32 v30, v30
  v_exp_f32 v31, v31
  v_exp_f32 v32, v32
  v_exp_f32 v33, v33
  v_mfma_f32_32x32x16_bf16 v[44:59], v[80:83], v[8:11], v[12:27]
  ds_read_b128 v[76:79], v2 offset:12288
  v_exp_f32 v34, v34
  v_exp_f32 v35, v35
  v_exp_f32 v36, v36
  v_exp_f32 v37, v37
  v_exp_f32 v38, v38
  v_smfmac_f32_32x32x32_bf16 v[60:75], v[84:87], v[28:35], v3
  v_exp_f32 v39, v39
  v_exp_f32 v40, v40
  v_exp_f32 v41, v41
  v_exp_f32 v42, v42
  v_exp_f32 v43, v43
  ds_read_b64 v[106:107], v126 offset:64
  s_waitcnt lgkmcnt(0)
  v_exp_f32 v44, v44
  v_exp_f32 v45, v45
  v_smfmac_f32_32x32x32_bf16 v[60:75], v[88:91], v[36:43], v3
  s_mov_b64 exec, s[32:33]
  ds_read_b128 v[84:87], v2 offset:13312
  ds_read_b128 v[88:91], v2 offset:13568
  s_mov_b64 exec, -1
  v_exp_f32 v46, v46
  v_exp_f32 v47, v47
  v_exp_f32 v48, v48
  v_exp_f32 v49, v49
  v_mfma_f32_32x32x16_bf16 v[28:43], v[76:79], v[8:11], v[12:27]
  ds_read_b128 v[80:83], v2 offset:14336
  v_exp_f32 v50, v50
  v_exp_f32 v51, v51
  v_exp_f32 v52, v52
  v_exp_f32 v53, v53
  v_exp_f32 v54, v54
  v_smfmac_f32_32x32x32_bf16 v[60:75], v[92:95], v[44:51], v3
  v_exp_f32 v55, v55
  v_exp_f32 v56, v56
  v_exp_f32 v57, v57
  v_exp_f32 v58, v58
  v_exp_f32 v59, v59
  s_waitcnt lgkmcnt(0)
  s_cmp_lg_u32 s100, 0
  s_cbranch_scc1 skip18
  s_mov_b32 s10, 0x200000
lw19:
  v_cmp_ne_u64 vcc, s[98:99], v[106:107]
  s_nop 3
  s_cbranch_vccz lw19_ok
  ds_read_b64 v[106:107], v126 offset:64
  s_waitcnt lgkmcnt(0)
  s_sub_u32 s10, s10, 1
  s_cbranch_scc0 lw19
lw19_ok:
skip18:
  v_exp_f32 v28, v28
  v_exp_f32 v29, v29
  v_smfmac_f32_32x32x32_bf16 v[60:75], v[96:99], v[52:59], v3
  s_mov_b64 exec, s[32:33]
  ds_read_b128 v[92:95], v2 offset:15360
  ds_read_b128 v[96:99], v2 offset:15616
  s_mov_b64 exec, -1
  v_exp_f32 v30, v30
  v_exp_f32 v31, v31
  v_exp_f32 v32, v32
  v_exp_f32 v33, v33
  v_mfma_f32_32x32x16_bf16 v[44:59], v[80:83], v[8:11], v[12:27]
  ds_read_b128 v[76:79], v2 offset:16384
  v_exp_f32 v34, v34
  v_exp_f32 v35, v35
  v_exp_f32 v36, v36
  v_exp_f32 v37, v37
  v_exp_f32 v38, v38
  v_smfmac_f32_32x32x32_bf16 v[60:75], v[84:87], v[28:35], v3
  v_exp_f32 v39, v39
  v_exp_f32 v40, v40
  v_exp_f32 v41, v41
  v_exp_f32 v42, v42
  v_exp_f32 v43, v43
  s_cmp_gt_u32 s18, s100
  s_cbranch_scc0 skip20
  s_setprio 0
skip20:
  s_cmp_gt_u32 s43, s100
  s_cbranch_scc0 skip21
  s_waitcnt vmcnt(0)
  s_lshl_b32 s3, s24, 3
  v_mov_b32 v5, s3
  v_add_u32 v5, 162784, v5
  v_mov_b32 v6, s98
  v_mov_b32 v7, s99
  ds_write_b64 v5, v[6:7] offset:0
skip21:
  s_cmp_lg_u32 s100, 0
  s_cbranch_scc1 skip22
  s_lshl_b32 s3, s29, 3
  s_add_u32 s3, s3, s24
  s_lshl_b32 s3, s3, 5
  s_add_u32 s3, s3, s28
  s_lshl_b32 s13, s3, 7
  s_add_u32 s13, s13, 13959168
  s_lshl_b32 s3, s3, 10
  s_add_u32 s12, s3, 8388608
  v_mov_b32 v104, -1
  v_mov_b32 v105, -1
  v_mov_b32 v106, -1
  v_mov_b32 v107, -1
  buffer_store_dwordx4 v[104:107], v1, s[20:23], s12 offen sc1
skip22:
  s_waitcnt lgkmcnt(0)
  v_exp_f32 v44, v44
  v_exp_f32 v45, v45
  v_smfmac_f32_32x32x32_bf16 v[60:75], v[88:91], v[36:43], v3
  s_mov_b64 exec, s[32:33]
  ds_read_b128 v[84:87], v2 offset:17408
  ds_read_b128 v[88:91], v2 offset:17664
  s_mov_b64 exec, -1
  v_exp_f32 v46, v46
  v_exp_f32 v47, v47
  v_exp_f32 v48, v48
  v_exp_f32 v49, v49
  v_mfma_f32_32x32x16_bf16 v[28:43], v[76:79], v[8:11], v[12:27]
  ds_read_b128 v[80:83], v2 offset:18432
  v_exp_f32 v50, v50
  v_exp_f32 v51, v51
  v_exp_f32 v52, v52
  v_exp_f32 v53, v53
  v_exp_f32 v54, v54
  v_smfmac_f32_32x32x32_bf16 v[60:75], v[92:95], v[44:51], v3
  v_exp_f32 v55, v55
  v_exp_f32 v56, v56
  v_exp_f32 v57, v57
  v_exp_f32 v58, v58
  v_exp_f32 v59, v59
  s_waitcnt lgkmcnt(0)
  v_exp_f32 v28, v28
  v_exp_f32 v29, v29
  v_smfmac_f32_32x32x32_bf16 v[60:75], v[96:99], v[52:59], v3
  s_mov_b64 exec, s[32:33]
  ds_read_b128 v[92:95], v2 offset:19456
  ds_read_b128 v[96:99], v2 offset:19712
  s_mov_b64 exec, -1
  v_exp_f32 v30, v30
  v_exp_f32 v31, v31
  v_exp_f32 v32, v32
  v_exp_f32 v33, v33
  v_mfma_f32_32x32x16_bf16 v[44:59], v[80:83], v[8:11], v[12:27]
  ds_read_b128 v[76:79], v2 offset:20480
  v_exp_f32 v34, v34
  v_exp_f32 v35, v35
  v_exp_f32 v36, v36
  v_exp_f32 v37, v37
  v_exp_f32 v38, v38
  v_smfmac_f32_32x32x32_bf16 v[60:75], v[84:87], v[28:35], v3
  v_exp_f32 v39, v39
  v_exp_f32 v40, v40
  v_exp_f32 v41, v41
  v_exp_f32 v42, v42
  v_exp_f32 v43, v43
  s_cmp_gt_u32 s18, s100
  s_cbranch_scc0 skip23
  s_setprio 2
skip23:
  s_waitcnt lgkmcnt(0)
  v_exp_f32 v44, v44
  v_exp_f32 v45, v45
  v_smfmac_f32_32x32x32_bf16 v[60:75], v[88:91], v[36:43], v3
  s_mov_b64 exec, s[32:33]
  ds_read_b128 v[84:87], v2 offset:21504
  ds_read_b128 v[88:91], v2 offset:21760
  s_mov_b64 exec, -1
  v_exp_f32 v46, v46
  v_exp_f32 v47, v47
  v_exp_f32 v48, v48
  v_exp_f32 v49, v49
  v_mfma_f32_32x32x16_bf16 v[28:43], v[76:79], v[8:11], v[12:27]
  ds_read_b128 v[80:83], v2 offset:22528
  v_exp_f32 v50, v50
  v_exp_f32 v51, v51
  v_exp_f32 v52, v52
  v_exp_f32 v53, v53
  v_exp_f32 v54, v54
  v_smfmac_f32_32x32x32_bf16 v[60:75], v[92:95], v[44:51], v3
  v_exp_f32 v55, v55
  v_exp_f32 v56, v56
  v_exp_f32 v57, v57
  v_exp_f32 v58, v58
  v_exp_f32 v59, v59
  s_cmp_gt_u32 s9, s100
  s_cbranch_scc0 skip24
  s_and_b32 s3, s2, 7
  s_lshl_b32 s3, s3, 4
  s_lshr_b32 s31, s2, 4
  s_add_u32 s31, s31, s3
  s_lshr_b32 s4, s31, 2
  s_and_b32 s5, s31, 3
  s_lshl_b32 s3, s4, 7
  s_lshl_b32 s3, s3, 4
  s_add_u32 s40, s3, 13697024
  v_and_b32 v5, 15, v0
  v_lshlrev_b32 v5, 7, v5
  buffer_load_dwordx2 v[102:103], v5, s[20:23], s40 offen sc1
skip24:
  s_waitcnt lgkmcnt(0)
  v_exp_f32 v28, v28
  v_exp_f32 v29, v29
  v_smfmac_f32_32x32x32_bf16 v[60:75], v[96:99], v[52:59], v3
  s_mov_b64 exec, s[32:33]
  ds_read_b128 v[92:95], v2 offset:23552
  ds_read_b128 v[96:99], v2 offset:23808
  s_mov_b64 exec, -1
  v_exp_f32 v30, v30
  v_exp_f32 v31, v31
  v_exp_f32 v32, v32
  v_exp_f32 v33, v33
  v_mfma_f32_32x32x16_bf16 v[44:59], v[80:83], v[8:11], v[12:27]
  ds_read_b128 v[76:79], v2 offset:24576
  v_exp_f32 v34, v34
  v_exp_f32 v35, v35
  v_exp_f32 v36, v36
  v_exp_f32 v37, v37
  v_exp_f32 v38, v38
  v_smfmac_f32_32x32x32_bf16 v[60:75], v[84:87], v[28:35], v3
  v_exp_f32 v39, v39
  v_exp_f32 v40, v40
  v_exp_f32 v41, v41
  v_exp_f32 v42, v42
  v_exp_f32 v43, v43
  s_cmp_gt_u32 s43, s100
  s_cbranch_scc0 skip25
  v_and_b32 v5, 31, v0
  v_lshlrev_b32 v5, 7, v5
  buffer_load_dwordx2 v[102:103], v5, s[20:23], s6 offen sc1
  s_and_b32 s3, s24, 3
  s_lshl_b32 s3, s3, 1
  v_and_b32 v5, 1, v0
  v_bfe_u32 v6, v0, 1, 2
  v_lshl_add_u32 v5, v6, 3, v5
  v_add_u32 v5, s3, v5
  v_lshlrev_b32 v5, 7, v5
  buffer_load_dwordx2 v[124:125], v5, s[20:23], s7 offen sc1
skip25:
  s_cmp_gt_u32 s18, s100
  s_cbranch_scc0 skip26
  s_waitcnt vmcnt(0)
  v_mov_b32 v6, s98
  v_mov_b32 v7, s99
  s_mov_b64 exec, 1
  buffer_store_dwordx2 v[6:7], off, s[20:23], s13 sc1
  s_mov_b64 exec, -1
skip26:
  s_waitcnt lgkmcnt(0)
  v_exp_f32 v44, v44
  v_exp_f32 v45, v45
  v_smfmac_f32_32x32x32_bf16 v[60:75], v[88:91], v[36:43], v3
  s_mov_b64 exec, s[32:33]
  ds_read_b128 v[84:87], v2 offset:25600
  ds_read_b128 v[88:91], v2 offset:25856
  s_mov_b64 exec, -1
  v_exp_f32 v46, v46
  v_exp_f32 v47, v47
  v_exp_f32 v48, v48
  v_exp_f32 v49, v49
  v_mfma_f32_32x32x16_bf16 v[28:43], v[76:79], v[8:11], v[12:27]
  ds_read_b128 v[80:83], v2 offset:26624
  v_exp_f32 v50, v50
  v_exp_f32 v51, v51
  v_exp_f32 v52, v52
  v_exp_f32 v53, v53
  v_exp_f32 v54, v54
  v_smfmac_f32_32x32x32_bf16 v[60:75], v[92:95], v[44:51], v3
  v_exp_f32 v55, v55
  v_exp_f32 v56, v56
  v_exp_f32 v57, v57
  v_exp_f32 v58, v58
  v_exp_f32 v59, v59
  s_cmp_gt_u32 s9, s100
  s_cbranch_scc0 skip27
  s_waitcnt vmcnt(0)
  v_cmp_ne_u64 vcc, s[98:99], v[102:103]
  s_nop 3
  s_cbranch_vccz seen28
  v_and_b32 v5, 15, v0
  v_lshlrev_b32 v5, 7, v5
  s_mov_b32 s10, 0x200000
poll29:
  buffer_load_dwordx2 v[6:7], v5, s[20:23], s40 offen sc1
  s_waitcnt vmcnt(0)
  v_cmp_ne_u64 vcc, s[98:99], v[6:7]
  s_nop 3
  s_cbranch_vccz poll29_ok
  s_sub_u32 s10, s10, 1
  s_cbranch_scc0 poll29
poll29_ok:
seen28:
  s_lshl_b32 s3, s4, 16
  s_lshl_b32 s30, s5, 10
  s_add_u32 s3, s3, s30
  s_add_u32 s3, s3, 10485760
  buffer_load_dwordx4 v[160:163], v1, s[20:23], s3 offen sc1
  s_add_u32 s3, s3, 4096
  buffer_load_dwordx4 v[164:167], v1, s[20:23], s3 offen sc1
  s_add_u32 s3, s3, 4096
  buffer_load_dwordx4 v[168:171], v1, s[20:23], s3 offen sc1
  s_add_u32 s3, s3, 4096
  buffer_load_dwordx4 v[172:175], v1, s[20:23], s3 offen sc1
  s_add_u32 s3, s3, 4096
  buffer_load_dwordx4 v[176:179], v1, s[20:23], s3 offen sc1
  s_add_u32 s3, s3, 4096
  buffer_load_dwordx4 v[180:183], v1, s[20:23], s3 offen sc1
  s_add_u32 s3, s3, 4096
  buffer_load_dwordx4 v[184:187], v1, s[20:23], s3 offen sc1
  s_add_u32 s3, s3, 4096
  buffer_load_dwordx4 v[188:191], v1, s[20:23], s3 offen sc1
  s_add_u32 s3, s3, 4096
  buffer_load_dwordx4 v[192:195], v1, s[20:23], s3 offen sc1
  s_add_u32 s3, s3, 4096
  buffer_load_dwordx4 v[196:199], v1, s[20:23], s3 offen sc1
  s_add_u32 s3, s3, 4096
  buffer_load_dwordx4 v[200:203], v1, s[20:23], s3 offen sc1
  s_add_u32 s3, s3, 4096
  buffer_load_dwordx4 v[204:207], v1, s[20:23], s3 offen sc1
  s_add_u32 s3, s3, 4096
  buffer_load_dwordx4 v[208:211], v1, s[20:23], s3 offen sc1
  s_add_u32 s3, s3, 4096
  buffer_load_dwordx4 v[212:215], v1, s[20:23], s3 offen sc1
  s_add_u32 s3, s3, 4096
  buffer_load_dwordx4 v[216:219], v1, s[20:23], s3 offen sc1
  s_add_u32 s3, s3, 4096
  buffer_load_dwordx4 v[220:223], v1, s[20:23], s3 offen sc1
  s_lshl_b32 s3, s4, 11
  s_lshr_b32 s30, s5, 1
  s_lshl_b32 s30, s30, 10
  s_add_u32 s3, s3, s30
  s_and_b32 s30, s5, 1
  s_lshl_b32 s30, s30, 3
  s_add_u32 s3, s3, s30
  s_add_u32 s19, s3, 12582912
  s_lshr_b32 s30, s31, 3
  s_lshl_b32 s30, s30, 7
  s_and_b32 s31, s31, 7
  s_lshl_b32 s31, s31, 3
  s_add_u32 s31, s31, s30
  s_lshl_b32 s31, s31, 4
  s_add_u32 s31, s31, 13762560
skip27:
  s_waitcnt lgkmcnt(0)
  v_exp_f32 v28, v28
  v_exp_f32 v29, v29
  v_smfmac_f32_32x32x32_bf16 v[60:75], v[96:99], v[52:59], v3
  s_mov_b64 exec, s[32:33]
  ds_read_b128 v[92:95], v2 offset:27648
  ds_read_b128 v[96:99], v2 offset:27904
  s_mov_b64 exec, -1
  v_exp_f32 v30, v30
  v_exp_f32 v31, v31
  v_exp_f32 v32, v32
  v_exp_f32 v33, v33
  v_mfma_f32_32x32x16_bf16 v[44:59], v[80:83], v[8:11], v[12:27]
  ds_read_b128 v[76:79], v2 offset:28672
  v_exp_f32 v34, v34
  v_exp_f32 v35, v35
  v_exp_f32 v36, v36
  v_exp_f32 v37, v37
  v_exp_f32 v38, v38
  v_smfmac_f32_32x32x32_bf16 v[60:75], v[84:87], v[28:35], v3
  v_exp_f32 v39, v39
  v_exp_f32 v40, v40
  v_exp_f32 v41, v41
  v_exp_f32 v42, v42
  v_exp_f32 v43, v43
  s_cmp_gt_u32 s43, s100
  s_cbranch_scc0 skip30
  s_waitcnt vmcnt(0)
  v_cmp_ne_u64 vcc, s[98:99], v[102:103]
  s_nop 3
  s_cbranch_vccz seen31
  v_and_b32 v5, 31, v0
  v_lshlrev_b32 v5, 7, v5
  s_mov_b32 s10, 0x200000
poll32:
  buffer_load_dwordx2 v[6:7], v5, s[20:23], s6 offen sc1
  s_waitcnt vmcnt(0)
  v_cmp_ne_u64 vcc, s[98:99], v[6:7]
  s_nop 3
  s_cbranch_vccz poll32_ok
  s_sub_u32 s10, s10, 1
  s_cbranch_scc0 poll32
poll32_ok:
seen31:
  v_cmp_ne_u64 vcc, s[98:99], v[124:125]
  s_nop 3
  s_cbranch_vccz seen33
  s_and_b32 s3, s24, 3
  s_lshl_b32 s3, s3, 1
  v_and_b32 v5, 1, v0
  v_bfe_u32 v6, v0, 1, 2
  v_lshl_add_u32 v5, v6, 3, v5
  v_add_u32 v5, s3, v5
  v_lshlrev_b32 v5, 7, v5
  s_mov_b32 s10, 0x200000
poll34:
  buffer_load_dwordx2 v[6:7], v5, s[20:23], s7 offen sc1
  s_waitcnt vmcnt(0)
  v_cmp_ne_u64 vcc, s[98:99], v[6:7]
  s_nop 3
  s_cbranch_vccz poll34_ok
  s_sub_u32 s10, s10, 1
  s_cbranch_scc0 poll34
poll34_ok:
seen33:
skip30:
  s_cmp_gt_u32 s43, s100
  s_cbranch_scc0 skip35
  s_add_u32 m0, s5, 65536
  s_add_u32 s3, m0, s4
  s_and_b32 s3, s3, 0x1ffff
  buffer_load_dwordx4 v1, s[44:47], s3 offen offset:0 sc1 lds
  buffer_load_dwordx4 v1, s[44:47], s3 offen offset:1024 sc1 lds
  buffer_load_dwordx4 v1, s[44:47], s3 offen offset:2048 sc1 lds
  buffer_load_dwordx4 v1, s[44:47], s3 offen offset:3072 sc1 lds
skip35:
  ds_read_b64 v[106:107], v126 offset:0
  s_waitcnt lgkmcnt(0)
  v_exp_f32 v44, v44
  v_exp_f32 v45, v45
  v_smfmac_f32_32x32x32_bf16 v[60:75], v[88:91], v[36:43], v3
  s_mov_b64 exec, s[32:33]
  ds_read_b128 v[84:87], v2 offset:29696
  ds_read_b128 v[88:91], v2 offset:29952
  s_mov_b64 exec, -1
  v_exp_f32 v46, v46
  v_exp_f32 v47, v47
  v_exp_f32 v48, v48
  v_exp_f32 v49, v49
  v_mfma_f32_32x32x16_bf16 v[28:43], v[76:79], v[8:11], v[12:27]
  ds_read_b128 v[80:83], v2 offset:30720
  v_exp_f32 v50, v50
  v_exp_f32 v51, v51
  v_exp_f32 v52, v52
  v_exp_f32 v53, v53
  v_exp_f32 v54, v54
  v_smfmac_f32_32x32x32_bf16 v[60:75], v[92:95], v[44:51], v3
  v_exp_f32 v55, v55
  v_exp_f32 v56, v56
  v_exp_f32 v57, v57
  v_exp_f32 v58, v58
  v_exp_f32 v59, v59
  s_cmp_gt_u32 s18, s100
  s_cbranch_scc0 skip36
  s_setprio 0
skip36:
  s_cmp_gt_u32 s43, s100
  s_cbranch_scc0 skip37
  s_add_u32 m0, s5, 81920
  s_add_u32 s3, m0, s4
  s_and_b32 s3, s3, 0x1ffff
  buffer_load_dwordx4 v1, s[44:47], s3 offen offset:0 sc1 lds
  buffer_load_dwordx4 v1, s[44:47], s3 offen offset:1024 sc1 lds
  buffer_load_dwordx4 v1, s[44:47], s3 offen offset:2048 sc1 lds
  buffer_load_dwordx4 v1, s[44:47], s3 offen offset:3072 sc1 lds
skip37:
  s_waitcnt lgkmcnt(0)
  s_cmp_lg_u32 s100, 0
  s_cbranch_scc1 skip38
  s_mov_b32 s10, 0x200000
lw39:
  v_cmp_ne_u64 vcc, s[98:99], v[106:107]
  s_nop 3
  s_cbranch_vccz lw39_ok
  ds_read_b64 v[106:107], v126 offset:0
  s_waitcnt lgkmcnt(0)
  s_sub_u32 s10, s10, 1
  s_cbranch_scc0 lw39
lw39_ok:
skip38:
  v_exp_f32 v28, v28
  v_exp_f32 v29, v29
  v_smfmac_f32_32x32x32_bf16 v[60:75], v[96:99], v[52:59], v3
  s_mov_b64 exec, s[32:33]
  ds_read_b128 v[92:95], v2 offset:31744
  ds_read_b128 v[96:99], v2 offset:32000
  s_mov_b64 exec, -1
  v_exp_f32 v30, v30
  v_exp_f32 v31, v31
  v_exp_f32 v32, v32
  v_exp_f32 v33, v33
  v_mfma_f32_32x32x16_bf16 v[44:59], v[80:83], v[8:11], v[12:27]
  ds_read_b128 v[76:79], v2 offset:32768
  v_exp_f32 v34, v34
  v_exp_f32 v35, v35
  v_exp_f32 v36, v36
  v_exp_f32 v37, v37
  v_exp_f32 v38, v38
  v_smfmac_f32_32x32x32_bf16 v[60:75], v[84:87], v[28:35], v3
  v_exp_f32 v39, v39
  v_exp_f32 v40, v40
  v_exp_f32 v41, v41
  v_exp_f32 v42, v42
  v_exp_f32 v43, v43
  s_cmp_gt_u32 s43, s100
  s_cbranch_scc0 skip40
  s_add_u32 m0, s5, 98304
  s_add_u32 s3, m0, s4
  s_and_b32 s3, s3, 0x1ffff
  buffer_load_dwordx4 v1, s[44:47], s3 offen offset:0 sc1 lds
  buffer_load_dwordx4 v1, s[44:47], s3 offen offset:1024 sc1 lds
  buffer_load_dwordx4 v1, s[44:47], s3 offen offset:2048 sc1 lds
  buffer_load_dwordx4 v1, s[44:47], s3 offen offset:3072 sc1 lds
skip40:
  s_cmp_gt_u32 s9, s100
  s_cbranch_scc0 skip41
  s_waitcnt vmcnt(0)
  v_pk_add_f32 v[160:161], v[160:161], v[192:193]
  v_pk_add_f32 v[162:163], v[162:163], v[194:195]
  v_pk_add_f32 v[164:165], v[164:165], v[196:197]
  v_pk_add_f32 v[166:167], v[166:167], v[198:199]
  v_pk_add_f32 v[168:169], v[168:169], v[200:201]
  v_pk_add_f32 v[170:171], v[170:171], v[202:203]
  v_pk_add_f32 v[172:173], v[172:173], v[204:205]
  v_pk_add_f32 v[174:175], v[174:175], v[206:207]
  v_pk_add_f32 v[176:177], v[176:177], v[208:209]
  v_pk_add_f32 v[178:179], v[178:179], v[210:211]
  v_pk_add_f32 v[180:181], v[180:181], v[212:213]
  v_pk_add_f32 v[182:183], v[182:183], v[214:215]
  v_pk_add_f32 v[184:185], v[184:185], v[216:217]
  v_pk_add_f32 v[186:187], v[186:187], v[218:219]
  v_pk_add_f32 v[188:189], v[188:189], v[220:221]
  v_pk_add_f32 v[190:191], v[190:191], v[222:223]
  v_pk_add_f32 v[160:161], v[160:161], v[176:177]
  v_pk_add_f32 v[162:163], v[162:163], v[178:179]
  v_pk_add_f32 v[164:165], v[164:165], v[180:181]
  v_pk_add_f32 v[166:167], v[166:167], v[182:183]
  v_pk_add_f32 v[168:169], v[168:169], v[184:185]
  v_pk_add_f32 v[170:171], v[170:171], v[186:187]
  v_pk_add_f32 v[172:173], v[172:173], v[188:189]
  v_pk_add_f32 v[174:175], v[174:175], v[190:191]
  v_pk_add_f32 v[160:161], v[160:161], v[168:169]
  v_pk_add_f32 v[162:163], v[162:163], v[170:171]
  v_pk_add_f32 v[164:165], v[164:165], v[172:173]
  v_pk_add_f32 v[166:167], v[166:167], v[174:175]
  v_pk_add_f32 v[160:161], v[160:161], v[164:165]
  v_pk_add_f32 v[162:163], v[162:163], v[166:167]
  v_cvt_pk_bf16_f32 v164, v160, v161
  v_cvt_pk_bf16_f32 v165, v162, v163
  buffer_store_dwordx2 v[164:165], v1, s[20:23], s19 offen sc1
skip41:
  s_waitcnt lgkmcnt(0)
  v_exp_f32 v44, v44
  v_exp_f32 v45, v45
  v_smfmac_f32_32x32x32_bf16 v[60:75], v[88:91], v[36:43], v3
  s_mov_b64 exec, s[32:33]
  ds_read_b128 v[84:87], v2 offset:33792
  ds_read_b128 v[88:91], v2 offset:34048
  s_mov_b64 exec, -1
  v_exp_f32 v46, v46
  v_exp_f32 v47, v47
  v_exp_f32 v48, v48
  v_exp_f32 v49, v49
  v_mfma_f32_32x32x16_bf16 v[28:43], v[76:79], v[8:11], v[12:27]
  ds_read_b128 v[80:83], v2 offset:34816
  v_exp_f32 v50, v50
  v_exp_f32 v51, v51
  v_exp_f32 v52, v52
  v_exp_f32 v53, v53
  v_exp_f32 v54, v54
  v_smfmac_f32_32x32x32_bf16 v[60:75], v[92:95], v[44:51], v3
  v_exp_f32 v55, v55
  v_exp_f32 v56, v56
  v_exp_f32 v57, v57
  v_exp_f32 v58, v58
  v_exp_f32 v59, v59
  s_cmp_gt_u32 s18, s100
  s_cbranch_scc0 skip42
  s_setprio 2
skip42:
  s_cmp_gt_u32 s43, s100
  s_cbranch_scc0 skip43
  s_add_u32 m0, s5, 114688
  s_add_u32 s3, m0, s4
  s_and_b32 s3, s3, 0x1ffff
  buffer_load_dwordx4 v1, s[44:47], s3 offen offset:0 sc1 lds
  buffer_load_dwordx4 v1, s[44:47], s3 offen offset:1024 sc1 lds
  buffer_load_dwordx4 v1, s[44:47], s3 offen offset:2048 sc1 lds
  buffer_load_dwordx4 v1, s[44:47], s3 offen offset:3072 sc1 lds
skip43:
  s_waitcnt lgkmcnt(0)
  v_exp_f32 v28, v28
  v_exp_f32 v29, v29
  v_smfmac_f32_32x32x32_bf16 v[60:75], v[96:99], v[52:59], v3
  s_mov_b64 exec, s[32:33]
  ds_read_b128 v[92:95], v2 offset:35840
  ds_read_b128 v[96:99], v2 offset:36096
  s_mov_b64 exec, -1
  v_exp_f32 v30, v30
  v_exp_f32 v31, v31
  v_exp_f32 v32, v32
  v_exp_f32 v33, v33
  v_mfma_f32_32x32x16_bf16 v[44:59], v[80:83], v[8:11], v[12:27]
  ds_read_b128 v[76:79], v2 offset:36864
  v_exp_f32 v34, v34
  v_exp_f32 v35, v35
  v_exp_f32 v36, v36
  v_exp_f32 v37, v37
  v_exp_f32 v38, v38
  v_smfmac_f32_32x32x32_bf16 v[60:75], v[84:87], v[28:35], v3
  v_exp_f32 v39, v39
  v_exp_f32 v40, v40
  v_exp_f32 v41, v41
  v_exp_f32 v42, v42
  v_exp_f32 v43, v43
  s_waitcnt lgkmcnt(0)
  v_exp_f32 v44, v44
  v_exp_f32 v45, v45
  v_smfmac_f32_32x32x32_bf16 v[60:75], v[88:91], v[36:43], v3
  s_mov_b64 exec, s[32:33]
  ds_read_b128 v[84:87], v2 offset:37888
  ds_read_b128 v[88:91], v2 offset:38144
  s_mov_b64 exec, -1
  v_exp_f32 v46, v46
  v_exp_f32 v47, v47
  v_exp_f32 v48, v48
  v_exp_f32 v49, v49
  v_mfma_f32_32x32x16_bf16 v[28:43], v[76:79], v[8:11], v[12:27]
  ds_read_b128 v[80:83], v2 offset:38912
  v_exp_f32 v50, v50
  v_exp_f32 v51, v51
  v_exp_f32 v52, v52
  v_exp_f32 v53, v53
  v_exp_f32 v54, v54
  v_smfmac_f32_32x32x32_bf16 v[60:75], v[92:95], v[44:51], v3
  v_exp_f32 v55, v55
  v_exp_f32 v56, v56
  v_exp_f32 v57, v57
  v_exp_f32 v58, v58
  v_exp_f32 v59, v59
  s_waitcnt lgkmcnt(0)
  v_exp_f32 v28, v28
  v_exp_f32 v29, v29
  v_smfmac_f32_32x32x32_bf16 v[60:75], v[96:99], v[52:59], v3
  s_mov_b64 exec, s[32:33]
  ds_read_b128 v[92:95], v2 offset:39936
  ds_read_b128 v[96:99], v2 offset:40192
  s_mov_b64 exec, -1
  v_exp_f32 v30, v30
  v_exp_f32 v31, v31
  v_exp_f32 v32, v32
  v_exp_f32 v33, v33
  v_mfma_f32_32x32x16_bf16 v[44:59], v[80:83], v[8:11], v[12:27]
  ds_read_b128 v[76:79], v2 offset:40960
  v_exp_f32 v34, v34
  v_exp_f32 v35, v35
  v_exp_f32 v36, v36
  v_exp_f32 v37, v37
  v_exp_f32 v38, v38
  v_smfmac_f32_32x32x32_bf16 v[60:75], v[84:87], v[28:35], v3
  v_exp_f32 v39, v39
  v_exp_f32 v40, v40
  v_exp_f32 v41, v41
  v_exp_f32 v42, v42
  v_exp_f32 v43, v43
  s_cmp_gt_u32 s9, s100
  s_cbranch_scc0 skip44
  s_waitcnt vmcnt(0)
  v_mov_b32 v6, s98
  v_mov_b32 v7, s99
  s_mov_b64 exec, 1
  buffer_store_dwordx2 v[6:7], off, s[20:23], s31 sc1
  s_mov_b64 exec, -1
skip44:
  s_waitcnt lgkmcnt(0)
  v_exp_f32 v44, v44
  v_exp_f32 v45, v45
  v_smfmac_f32_32x32x32_bf16 v[60:75], v[88:91], v[36:43], v3
  s_mov_b64 exec, s[32:33]
  ds_read_b128 v[84:87], v2 offset:41984
  ds_read_b128 v[88:91], v2 offset:42240
  s_mov_b64 exec, -1
  v_exp_f32 v46, v46
  v_exp_f32 v47, v47
  v_exp_f32 v48, v48
  v_exp_f32 v49, v49
  v_mfma_f32_32x32x16_bf16 v[28:43], v[76:79], v[8:11], v[12:27]
  ds_read_b128 v[80:83], v2 offset:43008
  v_exp_f32 v50, v50
  v_exp_f32 v51, v51
  v_exp_f32 v52, v52
  v_exp_f32 v53, v53
  v_exp_f32 v54, v54
  v_smfmac_f32_32x32x32_bf16 v[60:75], v[92:95], v[44:51], v3
  v_exp_f32 v55, v55
  v_exp_f32 v56, v56
  v_exp_f32 v57, v57
  v_exp_f32 v58, v58
  v_exp_f32 v59, v59
  s_waitcnt lgkmcnt(0)
  v_exp_f32 v28, v28
  v_exp_f32 v29, v29
  v_smfmac_f32_32x32x32_bf16 v[60:75], v[96:99], v[52:59], v3
  s_mov_b64 exec, s[32:33]
  ds_read_b128 v[92:95], v2 offset:44032
  ds_read_b128 v[96:99], v2 offset:44288
  s_mov_b64 exec, -1
  v_exp_f32 v30, v30
  v_exp_f32 v31, v31
  v_exp_f32 v32, v32
  v_exp_f32 v33, v33
  v_mfma_f32_32x32x16_bf16 v[44:59], v[80:83], v[8:11], v[12:27]
  ds_read_b128 v[76:79], v2 offset:45056
  v_exp_f32 v34, v34
  v_exp_f32 v35, v35
  v_exp_f32 v36, v36
  v_exp_f32 v37, v37
  v_exp_f32 v38, v38
  v_smfmac_f32_32x32x32_bf16 v[60:75], v[84:87], v[28:35], v3
  v_exp_f32 v39, v39
  v_exp_f32 v40, v40
  v_exp_f32 v41, v41
  v_exp_f32 v42, v42
  v_exp_f32 v43, v43
  s_cmp_gt_u32 s18, s100
  s_cbranch_scc0 skip45
  s_setprio 0
skip45:
  s_cmp_gt_u32 s43, s100
  s_cbranch_scc0 skip46
  s_waitcnt vmcnt(0)
  s_lshl_b32 s3, s24, 3
  v_mov_b32 v5, s3
  v_add_u32 v5, 162784, v5
  v_mov_b32 v6, s98
  v_mov_b32 v7, s99
  ds_write_b64 v5, v[6:7] offset:32
skip46:
  s_cmp_gt_u32 s43, s100
  s_cbranch_scc0 skip47
  v_mov_b32 v6, s98
  v_mov_b32 v7, s99
  s_mov_b64 exec, 1
  buffer_store_dwordx2 v[6:7], off, s[20:23], s13 sc1
  s_mov_b64 exec, -1
skip47:
  s_waitcnt lgkmcnt(0)
  v_exp_f32 v44, v44
  v_exp_f32 v45, v45
  v_smfmac_f32_32x32x32_bf16 v[60:75], v[88:91], v[36:43], v3
  s_mov_b64 exec, s[32:33]
  ds_read_b128 v[84:87], v2 offset:46080
  ds_read_b128 v[88:91], v2 offset:46336
  s_mov_b64 exec, -1
  v_exp_f32 v46, v46
  v_exp_f32 v47, v47
  v_exp_f32 v48, v48
  v_exp_f32 v49, v49
  v_mfma_f32_32x32x16_bf16 v[28:43], v[76:79], v[8:11], v[12:27]
  ds_read_b128 v[80:83], v2 offset:47104
  v_exp_f32 v50, v50
  v_exp_f32 v51, v51
  v_exp_f32 v52, v52
  v_exp_f32 v53, v53
  v_exp_f32 v54, v54
  v_smfmac_f32_32x32x32_bf16 v[60:75], v[92:95], v[44:51], v3
  v_exp_f32 v55, v55
  v_exp_f32 v56, v56
  v_exp_f32 v57, v57
  v_exp_f32 v58, v58
  v_exp_f32 v59, v59
  s_cmp_lg_u32 s100, 0
  s_cbranch_scc1 skip48
  s_lshl_b32 s4, s24, 12
  s_add_u32 s4, s4, 131072
  s_and_b32 s3, s24, 3
  s_lshl_b32 s5, s11, 2
  s_add_u32 s3, s3, s5
  s_lshl_b32 s5, s3, 6
  s_lshr_b32 s42, s24, 2
  s_lshl_b32 s42, s42, 4
  s_add_u32 s3, s3, s42
  s_lshl_b32 s42, s3, 15
  s_add_u32 s42, s42, 14680064
skip48:
  s_waitcnt lgkmcnt(0)
  v_exp_f32 v28, v28
  v_exp_f32 v29, v29
  v_smfmac_f32_32x32x32_bf16 v[60:75], v[96:99], v[52:59], v3
  s_mov_b64 exec, s[32:33]
  ds_read_b128 v[92:95], v2 offset:48128
  ds_read_b128 v[96:99], v2 offset:48384
  s_mov_b64 exec, -1
  v_exp_f32 v30, v30
  v_exp_f32 v31, v31
  v_exp_f32 v32, v32
  v_exp_f32 v33, v33
  v_mfma_f32_32x32x16_bf16 v[44:59], v[80:83], v[8:11], v[12:27]
  ds_read_b128 v[76:79], v2 offset:49152
  v_exp_f32 v34, v34
  v_exp_f32 v35, v35
  v_exp_f32 v36, v36
  v_exp_f32 v37, v37
  v_exp_f32 v38, v38
  v_smfmac_f32_32x32x32_bf16 v[60:75], v[84:87], v[28:35], v3
  v_exp_f32 v39, v39
  v_exp_f32 v40, v40
  v_exp_f32 v41, v41
  v_exp_f32 v42, v42
  v_exp_f32 v43, v43
  s_cmp_gt_u32 s18, s100
  s_cbranch_scc0 skip49
  s_setprio 2
skip49:
  s_waitcnt lgkmcnt(0)
  v_exp_f32 v44, v44
  v_exp_f32 v45, v45
  v_smfmac_f32_32x32x32_bf16 v[60:75], v[88:91], v[36:43], v3
  s_mov_b64 exec, s[32:33]
  ds_read_b128 v[84:87], v2 offset:50176
  ds_read_b128 v[88:91], v2 offset:50432
  s_mov_b64 exec, -1
  v_exp_f32 v46, v46
  v_exp_f32 v47, v47
  v_exp_f32 v48, v48
  v_exp_f32 v49, v49
  v_mfma_f32_32x32x16_bf16 v[28:43], v[76:79], v[8:11], v[12:27]
  ds_read_b128 v[80:83], v2 offset:51200
  v_exp_f32 v50, v50
  v_exp_f32 v51, v51
  v_exp_f32 v52, v52
  v_exp_f32 v53, v53
  v_exp_f32 v54, v54
  v_smfmac_f32_32x32x32_bf16 v[60:75], v[92:95], v[44:51], v3
  v_exp_f32 v55, v55
  v_exp_f32 v56, v56
  v_exp_f32 v57, v57
  v_exp_f32 v58, v58
  v_exp_f32 v59, v59
  s_waitcnt lgkmcnt(0)
  v_exp_f32 v28, v28
  v_exp_f32 v29, v29
  v_smfmac_f32_32x32x32_bf16 v[60:75], v[96:99], v[52:59], v3
  s_mov_b64 exec, s[32:33]
  ds_read_b128 v[92:95], v2 offset:52224
  ds_read_b128 v[96:99], v2 offset:52480
  s_mov_b64 exec, -1
  v_exp_f32 v30, v30
  v_exp_f32 v31, v31
  v_exp_f32 v32, v32
  v_exp_f32 v33, v33
  v_mfma_f32_32x32x16_bf16 v[44:59], v[80:83], v[8:11], v[12:27]
  ds_read_b128 v[76:79], v2 offset:53248
  v_exp_f32 v34, v34
  v_exp_f32 v35, v35
  v_exp_f32 v36, v36
  v_exp_f32 v37, v37
  v_exp_f32 v38, v38
  v_smfmac_f32_32x32x32_bf16 v[60:75], v[84:87], v[28:35], v3
  v_exp_f32 v39, v39
  v_exp_f32 v40, v40
  v_exp_f32 v41, v41
  v_exp_f32 v42, v42
  v_exp_f32 v43, v43
  s_cmp_gt_u32 s8, s100
  s_cbranch_scc0 skip50
  s_lshl_b32 s3, s7, 6
  s_lshl_b32 s3, s3, 4
  s_add_u32 s40, s3, 13762560
  v_and_b32 v5, 7, v0
  v_lshlrev_b32 v5, 7, v5
  buffer_load_dwordx2 v[102:103], v5, s[20:23], s40 offen sc1
skip50:
  s_waitcnt lgkmcnt(0)
  v_exp_f32 v44, v44
  v_exp_f32 v45, v45
  v_smfmac_f32_32x32x32_bf16 v[60:75], v[88:91], v[36:43], v3
  s_mov_b64 exec, s[32:33]
  ds_read_b128 v[84:87], v2 offset:54272
  ds_read_b128 v[88:91], v2 offset:54528
  s_mov_b64 exec, -1
  v_exp_f32 v46, v46
  v_exp_f32 v47, v47
  v_exp_f32 v48, v48
  v_exp_f32 v49, v49
  v_mfma_f32_32x32x16_bf16 v[28:43], v[76:79], v[8:11], v[12:27]
  ds_read_b128 v[80:83], v2 offset:55296
  v_exp_f32 v50, v50
  v_exp_f32 v51, v51
  v_exp_f32 v52, v52
  v_exp_f32 v53, v53
  v_exp_f32 v54, v54
  v_smfmac_f32_32x32x32_bf16 v[60:75], v[92:95], v[44:51], v3
  v_exp_f32 v55, v55
  v_exp_f32 v56, v56
  v_exp_f32 v57, v57
  v_exp_f32 v58, v58
  v_exp_f32 v59, v59
  s_waitcnt lgkmcnt(0)
  v_exp_f32 v28, v28
  v_exp_f32 v29, v29
  v_smfmac_f32_32x32x32_bf16 v[60:75], v[96:99], v[52:59], v3
  s_mov_b64 exec, s[32:33]
  ds_read_b128 v[92:95], v2 offset:56320
  ds_read_b128 v[96:99], v2 offset:56576
  s_mov_b64 exec, -1
  v_exp_f32 v30, v30
  v_exp_f32 v31, v31
  v_exp_f32 v32, v32
  v_exp_f32 v33, v33
  v_mfma_f32_32x32x16_bf16 v[44:59], v[80:83], v[8:11], v[12:27]
  ds_read_b128 v[76:79], v2 offset:57344
  v_exp_f32 v34, v34
  v_exp_f32 v35, v35
  v_exp_f32 v36, v36
  v_exp_f32 v37, v37
  v_exp_f32 v38, v38
  v_smfmac_f32_32x32x32_bf16 v[60:75], v[84:87], v[28:35], v3
  v_exp_f32 v39, v39
  v_exp_f32 v40, v40
  v_exp_f32 v41, v41
  v_exp_f32 v42, v42
  v_exp_f32 v43, v43
  s_cmp_gt_u32 s8, s100
  s_cbranch_scc0 skip51
  s_waitcnt vmcnt(0)
  v_cmp_ne_u64 vcc, s[98:99], v[102:103]
  s_nop 3
  s_cbranch_vccz seen52
  v_and_b32 v5, 7, v0
  v_lshlrev_b32 v5, 7, v5
  s_mov_b32 s10, 0x200000
poll53:
  buffer_load_dwordx2 v[6:7], v5, s[20:23], s40 offen sc1
  s_waitcnt vmcnt(0)
  v_cmp_ne_u64 vcc, s[98:99], v[6:7]
  s_nop 3
  s_cbranch_vccz poll53_ok
  s_sub_u32 s10, s10, 1
  s_cbranch_scc0 poll53
poll53_ok:
seen52:
  s_lshl_b32 s3, s7, 11
  s_add_u32 s3, s3, 12582912
  buffer_load_dwordx4 v[108:111], v1, s[20:23], s3 offen offset:0 sc1
  buffer_load_dwordx4 v[112:115], v1, s[20:23], s3 offen offset:1024 sc1
  buffer_load_dwordx4 v[116:119], v1, s[20:23], s3 offen offset:2048 sc1
  buffer_load_dwordx4 v[120:123], v1, s[20:23], s3 offen offset:3072 sc1
  s_lshl_b32 s3, s6, 5
  s_add_u32 s3, s3, s7
  s_lshl_b32 s3, s3, 10
  s_add_u32 s40, s3, 6291456
  s_add_u32 s41, s40, 32768
  s_lshl_b32 s31, s6, 11
  s_lshl_b32 s3, s7, 6
  s_add_u32 s31, s31, s3
  s_add_u32 s31, s31, 13828096
skip51:
  s_waitcnt lgkmcnt(0)
  v_exp_f32 v44, v44
  v_exp_f32 v45, v45
  v_smfmac_f32_32x32x32_bf16 v[60:75], v[88:91], v[36:43], v3
  s_mov_b64 exec, s[32:33]
  ds_read_b128 v[84:87], v2 offset:58368
  ds_read_b128 v[88:91], v2 offset:58624
  s_mov_b64 exec, -1
  v_exp_f32 v46, v46
  v_exp_f32 v47, v47
  v_exp_f32 v48, v48
  v_exp_f32 v49, v49
  v_mfma_f32_32x32x16_bf16 v[28:43], v[76:79], v[8:11], v[12:27]
  ds_read_b128 v[80:83], v2 offset:59392
  v_exp_f32 v50, v50
  v_exp_f32 v51, v51
  v_exp_f32 v52, v52
  v_exp_f32 v53, v53
  v_exp_f32 v54, v54
  v_smfmac_f32_32x32x32_bf16 v[60:75], v[92:95], v[44:51], v3
  v_exp_f32 v55, v55
  v_exp_f32 v56, v56
  v_exp_f32 v57, v57
  v_exp_f32 v58, v58
  v_exp_f32 v59, v59
  s_cmp_gt_u32 s18, s100
  s_cbranch_scc0 skip54
  s_setprio 0
skip54:
  s_waitcnt lgkmcnt(0)
  v_exp_f32 v28, v28
  v_exp_f32 v29, v29
  v_smfmac_f32_32x32x32_bf16 v[60:75], v[96:99], v[52:59], v3
  s_mov_b64 exec, s[32:33]
  ds_read_b128 v[92:95], v2 offset:60416
  ds_read_b128 v[96:99], v2 offset:60672
  s_mov_b64 exec, -1
  v_exp_f32 v30, v30
  v_exp_f32 v31, v31
  v_exp_f32 v32, v32
  v_exp_f32 v33, v33
  v_mfma_f32_32x32x16_bf16 v[44:59], v[80:83], v[8:11], v[12:27]
  ds_read_b128 v[76:79], v2 offset:61440
  v_exp_f32 v34, v34
  v_exp_f32 v35, v35
  v_exp_f32 v36, v36
  v_exp_f32 v37, v37
  v_exp_f32 v38, v38
  v_smfmac_f32_32x32x32_bf16 v[60:75], v[84:87], v[28:35], v3
  v_exp_f32 v39, v39
  v_exp_f32 v40, v40
  v_exp_f32 v41, v41
  v_exp_f32 v42, v42
  v_exp_f32 v43, v43
  ds_read_b64 v[106:107], v126 offset:32
  s_waitcnt lgkmcnt(0)
  v_exp_f32 v44, v44
  v_exp_f32 v45, v45
  v_smfmac_f32_32x32x32_bf16 v[60:75], v[88:91], v[36:43], v3
  s_mov_b64 exec, s[32:33]
  ds_read_b128 v[84:87], v2 offset:62464
  ds_read_b128 v[88:91], v2 offset:62720
  s_mov_b64 exec, -1
  v_exp_f32 v46, v46
  v_exp_f32 v47, v47
  v_exp_f32 v48, v48
  v_exp_f32 v49, v49
  v_mfma_f32_32x32x16_bf16 v[28:43], v[76:79], v[8:11], v[12:27]
  ds_read_b128 v[80:83], v2 offset:63488
  v_exp_f32 v50, v50
  v_exp_f32 v51, v51
  v_exp_f32 v52, v52
  v_exp_f32 v53, v53
  v_exp_f32 v54, v54
  v_smfmac_f32_32x32x32_bf16 v[60:75], v[92:95], v[44:51], v3
  v_exp_f32 v55, v55
  v_exp_f32 v56, v56
  v_exp_f32 v57, v57
  v_exp_f32 v58, v58
  v_exp_f32 v59, v59
  s_cmp_gt_u32 s18, s100
  s_cbranch_scc0 skip55
  s_setprio 2
skip55:
  s_cmp_gt_u32 s8, s100
  s_cbranch_scc0 skip56
  s_waitcnt vmcnt(0)
  v_mfma_f32_32x32x16_bf16 v[128:143], v[108:111], v[160:163], 0
  v_mfma_f32_32x32x16_bf16 v[128:143], v[112:115], v[164:167], v[128:143]
  v_mfma_f32_32x32x16_bf16 v[144:159], v[108:111], v[176:179], 0
  v_mfma_f32_32x32x16_bf16 v[144:159], v[112:115], v[180:183], v[144:159]
skip56:
  s_waitcnt lgkmcnt(0)
  s_cmp_lg_u32 s100, 0
  s_cbranch_scc1 skip57
  s_mov_b32 s10, 0x200000
lw58:
  v_cmp_ne_u64 vcc, s[98:99], v[106:107]
  s_nop 3
  s_cbranch_vccz lw58_ok
  ds_read_b64 v[106:107], v126 offset:32
  s_waitcnt lgkmcnt(0)
  s_sub_u32 s10, s10, 1
  s_cbranch_scc0 lw58
lw58_ok:
skip57:
  s_add_u32 s19, s42, 28672
  buffer_load_dwordx4 v[252:255], v1, s[20:23], s19 offen offset:3072 sc1
  buffer_load_dwordx4 v[248:251], v1, s[20:23], s19 offen offset:2048 sc1
  v_exp_f32 v28, v28
  v_exp_f32 v29, v29
  v_smfmac_f32_32x32x32_bf16 v[60:75], v[96:99], v[52:59], v3
  s_mov_b64 exec, s[32:33]
  ds_read_b128 v[92:95], v2 offset:64512
  ds_read_b128 v[96:99], v2 offset:64768
  s_mov_b64 exec, -1
  v_exp_f32 v30, v30
  v_exp_f32 v31, v31
  v_exp_f32 v32, v32
  v_exp_f32 v33, v33
  v_mfma_f32_32x32x16_bf16 v[44:59], v[80:83], v[8:11], v[12:27]
  v_add_u32 v2, 65536, v2
  ds_read_b128 v[76:79], v2 offset:0
  v_exp_f32 v34, v34
  v_exp_f32 v35, v35
  v_exp_f32 v36, v36
  v_exp_f32 v37, v37
  v_exp_f32 v38, v38
  v_smfmac_f32_32x32x32_bf16 v[60:75], v[84:87], v[28:35], v3
  v_exp_f32 v39, v39
  v_exp_f32 v40, v40
  v_exp_f32 v41, v41
  v_exp_f32 v42, v42
  v_exp_f32 v43, v43
  s_cmp_gt_u32 s8, s100
  s_cbranch_scc0 skip59
  v_add_f32 v136, 0x358637bd, v136
  v_add_f32 v152, 0x358637bd, v152
  v_rcp_f32 v136, v136
  v_rcp_f32 v152, v152
  v_mul_f32 v128, v128, v136
  v_mul_f32 v129, v129, v136
  v_mul_f32 v130, v130, v136
  v_mul_f32 v131, v131, v136
  v_mul_f32 v132, v132, v136
  v_mul_f32 v133, v133, v136
  v_mul_f32 v134, v134, v136
  v_mul_f32 v135, v135, v136
  v_cvt_pk_bf16_f32 v160, v128, v129
  v_cvt_pk_bf16_f32 v161, v130, v131
  v_cvt_pk_bf16_f32 v162, v132, v133
  v_cvt_pk_bf16_f32 v163, v134, v135
  buffer_store_dwordx4 v[160:163], v1, s[20:23], s40 offen offset:0 sc1
  v_mul_f32 v144, v144, v152
  v_mul_f32 v145, v145, v152
  v_mul_f32 v146, v146, v152
  v_mul_f32 v147, v147, v152
  v_mul_f32 v148, v148, v152
  v_mul_f32 v149, v149, v152
  v_mul_f32 v150, v150, v152
  v_mul_f32 v151, v151, v152
  v_cvt_pk_bf16_f32 v176, v144, v145
  v_cvt_pk_bf16_f32 v177, v146, v147
  v_cvt_pk_bf16_f32 v178, v148, v149
  v_cvt_pk_bf16_f32 v179, v150, v151
  buffer_store_dwordx4 v[176:179], v1, s[20:23], s41 offen offset:0 sc1
  v_mfma_f32_32x32x16_bf16 v[128:143], v[116:119], v[168:171], 0
  v_mfma_f32_32x32x16_bf16 v[128:143], v[120:123], v[172:175], v[128:143]
  v_mfma_f32_32x32x16_bf16 v[144:159], v[116:119], v[184:187], 0
  v_mfma_f32_32x32x16_bf16 v[144:159], v[120:123], v[188:191], v[144:159]
skip59:
  buffer_load_dwordx4 v[244:247], v1, s[20:23], s19 offen offset:1024 sc1
  buffer_load_dwordx4 v[240:243], v1, s[20:23], s19 offen offset:0 sc1
  s_waitcnt lgkmcnt(0)
  v_exp_f32 v44, v44
  v_exp_f32 v45, v45
  v_smfmac_f32_32x32x32_bf16 v[60:75], v[88:91], v[36:43], v3
  s_mov_b64 exec, s[32:33]
  ds_read_b128 v[84:87], v2 offset:1024
  ds_read_b128 v[88:91], v2 offset:1280
  s_mov_b64 exec, -1
  v_exp_f32 v46, v46
  v_exp_f32 v47, v47
  v_exp_f32 v48, v48
  v_exp_f32 v49, v49
  v_mfma_f32_32x32x16_bf16 v[28:43], v[76:79], v[8:11], v[12:27]
  ds_read_b128 v[80:83], v2 offset:2048
  v_exp_f32 v50, v50
  v_exp_f32 v51, v51
  v_exp_f32 v52, v52
  v_exp_f32 v53, v53
  v_exp_f32 v54, v54
  v_smfmac_f32_32x32x32_bf16 v[60:75], v[92:95], v[44:51], v3
  v_exp_f32 v55, v55
  v_exp_f32 v56, v56
  v_exp_f32 v57, v57
  v_exp_f32 v58, v58
  v_exp_f32 v59, v59
  s_cmp_gt_u32 s8, s100
  s_cbranch_scc0 skip60
  v_add_f32 v128, 0x358637bd, v128
  v_add_f32 v144, 0x358637bd, v144
  v_rcp_f32 v128, v128
  v_rcp_f32 v144, v144
  v_mul_f32 v136, v136, v128
  v_mul_f32 v137, v137, v128
  v_mul_f32 v138, v138, v128
  v_mul_f32 v139, v139, v128
  v_mul_f32 v140, v140, v128
  v_mul_f32 v141, v141, v128
  v_mul_f32 v142, v142, v128
  v_mul_f32 v143, v143, v128
  v_cvt_pk_bf16_f32 v168, v136, v137
  v_cvt_pk_bf16_f32 v169, v138, v139
  v_cvt_pk_bf16_f32 v170, v140, v141
  v_cvt_pk_bf16_f32 v171, v142, v143
  buffer_store_dwordx4 v[168:171], v1, s[20:23], s40 offen offset:1024 sc1
  v_mul_f32 v152, v152, v144
  v_mul_f32 v153, v153, v144
  v_mul_f32 v154, v154, v144
  v_mul_f32 v155, v155, v144
  v_mul_f32 v156, v156, v144
  v_mul_f32 v157, v157, v144
  v_mul_f32 v158, v158, v144
  v_mul_f32 v159, v159, v144
  v_cvt_pk_bf16_f32 v184, v152, v153
  v_cvt_pk_bf16_f32 v185, v154, v155
  v_cvt_pk_bf16_f32 v186, v156, v157
  v_cvt_pk_bf16_f32 v187, v158, v159
  buffer_store_dwordx4 v[184:187], v1, s[20:23], s41 offen offset:1024 sc1
skip60:
  s_add_u32 s19, s42, 24576
  buffer_load_dwordx4 v[236:239], v1, s[20:23], s19 offen offset:3072 sc1
  buffer_load_dwordx4 v[232:235], v1, s[20:23], s19 offen offset:2048 sc1
  s_waitcnt lgkmcnt(0)
  v_exp_f32 v28, v28
  v_exp_f32 v29, v29
  v_smfmac_f32_32x32x32_bf16 v[60:75], v[96:99], v[52:59], v3
  s_mov_b64 exec, s[32:33]
  ds_read_b128 v[92:95], v2 offset:3072
  ds_read_b128 v[96:99], v2 offset:3328
  s_mov_b64 exec, -1
  v_exp_f32 v30, v30
  v_exp_f32 v31, v31
  v_exp_f32 v32, v32
  v_exp_f32 v33, v33
  v_mfma_f32_32x32x16_bf16 v[44:59], v[80:83], v[8:11], v[12:27]
  ds_read_b128 v[76:79], v2 offset:4096
  v_exp_f32 v34, v34
  v_exp_f32 v35, v35
  v_exp_f32 v36, v36
  v_exp_f32 v37, v37
  v_exp_f32 v38, v38
  v_smfmac_f32_32x32x32_bf16 v[60:75], v[84:87], v[28:35], v3
  v_exp_f32 v39, v39
  v_exp_f32 v40, v40
  v_exp_f32 v41, v41
  v_exp_f32 v42, v42
  v_exp_f32 v43, v43
  buffer_load_dwordx4 v[228:231], v1, s[20:23], s19 offen offset:1024 sc1
  buffer_load_dwordx4 v[224:227], v1, s[20:23], s19 offen offset:0 sc1
  s_waitcnt lgkmcnt(0)
  v_exp_f32 v44, v44
  v_exp_f32 v45, v45
  v_smfmac_f32_32x32x32_bf16 v[60:75], v[88:91], v[36:43], v3
  s_mov_b64 exec, s[32:33]
  ds_read_b128 v[84:87], v2 offset:5120
  ds_read_b128 v[88:91], v2 offset:5376
  s_mov_b64 exec, -1
  v_exp_f32 v46, v46
  v_exp_f32 v47, v47
  v_exp_f32 v48, v48
  v_exp_f32 v49, v49
  v_mfma_f32_32x32x16_bf16 v[28:43], v[76:79], v[8:11], v[12:27]
  ds_read_b128 v[80:83], v2 offset:6144
  v_exp_f32 v50, v50
  v_exp_f32 v51, v51
  v_exp_f32 v52, v52
  v_exp_f32 v53, v53
  v_exp_f32 v54, v54
  v_smfmac_f32_32x32x32_bf16 v[60:75], v[92:95], v[44:51], v3
  v_exp_f32 v55, v55
  v_exp_f32 v56, v56
  v_exp_f32 v57, v57
  v_exp_f32 v58, v58
  v_exp_f32 v59, v59
  s_add_u32 s19, s42, 20480
  buffer_load_dwordx4 v[220:223], v1, s[20:23], s19 offen offset:3072 sc1
  buffer_load_dwordx4 v[216:219], v1, s[20:23], s19 offen offset:2048 sc1
  s_waitcnt lgkmcnt(0)
  v_exp_f32 v28, v28
  v_exp_f32 v29, v29
  v_smfmac_f32_32x32x32_bf16 v[60:75], v[96:99], v[52:59], v3
  s_mov_b64 exec, s[32:33]
  ds_read_b128 v[92:95], v2 offset:7168
  ds_read_b128 v[96:99], v2 offset:7424
  s_mov_b64 exec, -1
  v_exp_f32 v30, v30
  v_exp_f32 v31, v31
  v_exp_f32 v32, v32
  v_exp_f32 v33, v33
  v_mfma_f32_32x32x16_bf16 v[44:59], v[80:83], v[8:11], v[12:27]
  ds_read_b128 v[76:79], v2 offset:8192
  v_exp_f32 v34, v34
  v_exp_f32 v35, v35
  v_exp_f32 v36, v36
  v_exp_f32 v37, v37
  v_exp_f32 v38, v38
  v_smfmac_f32_32x32x32_bf16 v[60:75], v[84:87], v[28:35], v3
  v_exp_f32 v39, v39
  v_exp_f32 v40, v40
  v_exp_f32 v41, v41
  v_exp_f32 v42, v42
  v_exp_f32 v43, v43
  s_cmp_gt_u32 s18, s100
  s_cbranch_scc0 skip61
  s_setprio 0
skip61:
  buffer_load_dwordx4 v[212:215], v1, s[20:23], s19 offen offset:1024 sc1
  buffer_load_dwordx4 v[208:211], v1, s[20:23], s19 offen offset:0 sc1
  s_waitcnt lgkmcnt(0)
  v_exp_f32 v44, v44
  v_exp_f32 v45, v45
  v_smfmac_f32_32x32x32_bf16 v[60:75], v[88:91], v[36:43], v3
  s_mov_b64 exec, s[32:33]
  ds_read_b128 v[84:87], v2 offset:9216
  ds_read_b128 v[88:91], v2 offset:9472
  s_mov_b64 exec, -1
  v_exp_f32 v46, v46
  v_exp_f32 v47, v47
  v_exp_f32 v48, v48
  v_exp_f32 v49, v49
  v_mfma_f32_32x32x16_bf16 v[28:43], v[76:79], v[8:11], v[12:27]
  ds_read_b128 v[80:83], v2 offset:10240
  v_exp_f32 v50, v50
  v_exp_f32 v51, v51
  v_exp_f32 v52, v52
  v_exp_f32 v53, v53
  v_exp_f32 v54, v54
  v_smfmac_f32_32x32x32_bf16 v[60:75], v[92:95], v[44:51], v3
  v_exp_f32 v55, v55
  v_exp_f32 v56, v56
  v_exp_f32 v57, v57
  v_exp_f32 v58, v58
  v_exp_f32 v59, v59
  s_cmp_gt_u32 s8, s100
  s_cbranch_scc0 skip62
  s_waitcnt vmcnt(8)
  v_mov_b32 v6, s98
  v_mov_b32 v7, s99
  s_mov_b64 exec, 1
  buffer_store_dwordx2 v[6:7], off, s[20:23], s31 sc1
  s_mov_b64 exec, -1
  s_add_u32 s31, s31, 2048
  v_mov_b32 v6, s98
  v_mov_b32 v7, s99
  s_mov_b64 exec, 1
  buffer_store_dwordx2 v[6:7], off, s[20:23], s31 sc1
  s_mov_b64 exec, -1
skip62:
  s_add_u32 s19, s42, 16384
  buffer_load_dwordx4 v[204:207], v1, s[20:23], s19 offen offset:3072 sc1
  buffer_load_dwordx4 v[200:203], v1, s[20:23], s19 offen offset:2048 sc1
  s_waitcnt lgkmcnt(0)
  v_exp_f32 v28, v28
  v_exp_f32 v29, v29
  v_smfmac_f32_32x32x32_bf16 v[60:75], v[96:99], v[52:59], v3
  s_mov_b64 exec, s[32:33]
  ds_read_b128 v[92:95], v2 offset:11264
  ds_read_b128 v[96:99], v2 offset:11520
  s_mov_b64 exec, -1
  v_exp_f32 v30, v30
  v_exp_f32 v31, v31
  v_exp_f32 v32, v32
  v_exp_f32 v33, v33
  v_mfma_f32_32x32x16_bf16 v[44:59], v[80:83], v[8:11], v[12:27]
  ds_read_b128 v[76:79], v2 offset:12288
  v_exp_f32 v34, v34
  v_exp_f32 v35, v35
  v_exp_f32 v36, v36
  v_exp_f32 v37, v37
  v_exp_f32 v38, v38
  v_smfmac_f32_32x32x32_bf16 v[60:75], v[84:87], v[28:35], v3
  v_exp_f32 v39, v39
  v_exp_f32 v40, v40
  v_exp_f32 v41, v41
  v_exp_f32 v42, v42
  v_exp_f32 v43, v43
  s_cmp_gt_u32 s18, s100
  s_cbranch_scc0 skip63
  s_setprio 2
skip63:
  buffer_load_dwordx4 v[196:199], v1, s[20:23], s19 offen offset:1024 sc1
  buffer_load_dwordx4 v[192:195], v1, s[20:23], s19 offen offset:0 sc1
  s_waitcnt lgkmcnt(0)
  v_exp_f32 v44, v44
  v_exp_f32 v45, v45
  v_smfmac_f32_32x32x32_bf16 v[60:75], v[88:91], v[36:43], v3
  s_mov_b64 exec, s[32:33]
  ds_read_b128 v[84:87], v2 offset:13312
  ds_read_b128 v[88:91], v2 offset:13568
  s_mov_b64 exec, -1
  v_exp_f32 v46, v46
  v_exp_f32 v47, v47
  v_exp_f32 v48, v48
  v_exp_f32 v49, v49
  v_mfma_f32_32x32x16_bf16 v[28:43], v[76:79], v[8:11], v[12:27]
  ds_read_b128 v[80:83], v2 offset:14336
  v_exp_f32 v50, v50
  v_exp_f32 v51, v51
  v_exp_f32 v52, v52
  v_exp_f32 v53, v53
  v_exp_f32 v54, v54
  v_smfmac_f32_32x32x32_bf16 v[60:75], v[92:95], v[44:51], v3
  v_exp_f32 v55, v55
  v_exp_f32 v56, v56
  v_exp_f32 v57, v57
  v_exp_f32 v58, v58
  v_exp_f32 v59, v59
  s_add_u32 s19, s42, 12288
  buffer_load_dwordx4 v[188:191], v1, s[20:23], s19 offen offset:3072 sc1
  buffer_load_dwordx4 v[184:187], v1, s[20:23], s19 offen offset:2048 sc1
  s_waitcnt lgkmcnt(0)
  v_exp_f32 v28, v28
  v_exp_f32 v29, v29
  v_smfmac_f32_32x32x32_bf16 v[60:75], v[96:99], v[52:59], v3
  s_mov_b64 exec, s[32:33]
  ds_read_b128 v[92:95], v2 offset:15360
  ds_read_b128 v[96:99], v2 offset:15616
  s_mov_b64 exec, -1
  v_exp_f32 v30, v30
  v_exp_f32 v31, v31
  v_exp_f32 v32, v32
  v_exp_f32 v33, v33
  v_mfma_f32_32x32x16_bf16 v[44:59], v[80:83], v[8:11], v[12:27]
  ds_read_b128 v[76:79], v2 offset:16384
  v_exp_f32 v34, v34
  v_exp_f32 v35, v35
  v_exp_f32 v36, v36
  v_exp_f32 v37, v37
  v_exp_f32 v38, v38
  v_smfmac_f32_32x32x32_bf16 v[60:75], v[84:87], v[28:35], v3
  v_exp_f32 v39, v39
  v_exp_f32 v40, v40
  v_exp_f32 v41, v41
  v_exp_f32 v42, v42
  v_exp_f32 v43, v43
  buffer_load_dwordx4 v[180:183], v1, s[20:23], s19 offen offset:1024 sc1
  s_waitcnt lgkmcnt(0)
  v_exp_f32 v44, v44
  v_exp_f32 v45, v45
  v_smfmac_f32_32x32x32_bf16 v[60:75], v[88:91], v[36:43], v3
  s_mov_b64 exec, s[32:33]
  ds_read_b128 v[84:87], v2 offset:17408
  ds_read_b128 v[88:91], v2 offset:17664
  s_mov_b64 exec, -1
  v_exp_f32 v46, v46
  v_exp_f32 v47, v47
  v_exp_f32 v48, v48
  v_exp_f32 v49, v49
  v_mfma_f32_32x32x16_bf16 v[28:43], v[76:79], v[8:11], v[12:27]
  ds_read_b128 v[80:83], v2 offset:18432
  v_exp_f32 v50, v50
  v_exp_f32 v51, v51
  v_exp_f32 v52, v52
  v_exp_f32 v53, v53
  v_exp_f32 v54, v54
  v_smfmac_f32_32x32x32_bf16 v[60:75], v[92:95], v[44:51], v3
  v_exp_f32 v55, v55
  v_exp_f32 v56, v56
  v_exp_f32 v57, v57
  v_exp_f32 v58, v58
  v_exp_f32 v59, v59
  buffer_load_dwordx4 v[176:179], v1, s[20:23], s19 offen offset:0 sc1
  s_waitcnt lgkmcnt(0)
  v_exp_f32 v28, v28
  v_exp_f32 v29, v29
  v_smfmac_f32_32x32x32_bf16 v[60:75], v[96:99], v[52:59], v3
  s_mov_b64 exec, s[32:33]
  ds_read_b128 v[92:95], v2 offset:19456
  ds_read_b128 v[96:99], v2 offset:19712
  s_mov_b64 exec, -1
  v_exp_f32 v30, v30
  v_exp_f32 v31, v31
  v_exp_f32 v32, v32
  v_exp_f32 v33, v33
  v_mfma_f32_32x32x16_bf16 v[44:59], v[80:83], v[8:11], v[12:27]
  ds_read_b128 v[76:79], v2 offset:20480
  v_exp_f32 v34, v34
  v_exp_f32 v35, v35
  v_exp_f32 v36, v36
  v_exp_f32 v37, v37
  v_exp_f32 v38, v38
  v_smfmac_f32_32x32x32_bf16 v[60:75], v[84:87], v[28:35], v3
  v_exp_f32 v39, v39
  v_exp_f32 v40, v40
  v_exp_f32 v41, v41
  v_exp_f32 v42, v42
  v_exp_f32 v43, v43
  s_add_u32 s19, s42, 8192
  buffer_load_dwordx4 v[172:175], v1, s[20:23], s19 offen offset:3072 sc1
  s_waitcnt lgkmcnt(0)
  v_exp_f32 v44, v44
  v_exp_f32 v45, v45
  v_smfmac_f32_32x32x32_bf16 v[60:75], v[88:91], v[36:43], v3
  s_mov_b64 exec, s[32:33]
  ds_read_b128 v[84:87], v2 offset:21504
  ds_read_b128 v[88:91], v2 offset:21760
  s_mov_b64 exec, -1
  v_exp_f32 v46, v46
  v_exp_f32 v47, v47
  v_exp_f32 v48, v48
  v_exp_f32 v49, v49
  v_mfma_f32_32x32x16_bf16 v[28:43], v[76:79], v[8:11], v[12:27]
  ds_read_b128 v[80:83], v2 offset:22528
  v_exp_f32 v50, v50
  v_exp_f32 v51, v51
  v_exp_f32 v52, v52
  v_exp_f32 v53, v53
  v_exp_f32 v54, v54
  v_smfmac_f32_32x32x32_bf16 v[60:75], v[92:95], v[44:51], v3
  v_exp_f32 v55, v55
  v_exp_f32 v56, v56
  v_exp_f32 v57, v57
  v_exp_f32 v58, v58
  v_exp_f32 v59, v59
  s_cmp_gt_u32 s18, s100
  s_cbranch_scc0 skip64
  s_setprio 0
skip64:
  buffer_load_dwordx4 v[168:171], v1, s[20:23], s19 offen offset:2048 sc1
  s_waitcnt lgkmcnt(0)
  v_exp_f32 v28, v28
  v_exp_f32 v29, v29
  v_smfmac_f32_32x32x32_bf16 v[60:75], v[96:99], v[52:59], v3
  s_mov_b64 exec, s[32:33]
  ds_read_b128 v[92:95], v2 offset:23552
  ds_read_b128 v[96:99], v2 offset:23808
  s_mov_b64 exec, -1
  v_exp_f32 v30, v30
  v_exp_f32 v31, v31
  v_exp_f32 v32, v32
  v_exp_f32 v33, v33
  v_mfma_f32_32x32x16_bf16 v[44:59], v[80:83], v[8:11], v[12:27]
  ds_read_b128 v[76:79], v2 offset:24576
  v_exp_f32 v34, v34
  v_exp_f32 v35, v35
  v_exp_f32 v36, v36
  v_exp_f32 v37, v37
  v_exp_f32 v38, v38
  v_smfmac_f32_32x32x32_bf16 v[60:75], v[84:87], v[28:35], v3
  v_exp_f32 v39, v39
  v_exp_f32 v40, v40
  v_exp_f32 v41, v41
  v_exp_f32 v42, v42
  v_exp_f32 v43, v43
  buffer_load_dwordx4 v[164:167], v1, s[20:23], s19 offen offset:1024 sc1
  s_waitcnt lgkmcnt(0)
  v_exp_f32 v44, v44
  v_exp_f32 v45, v45
  v_smfmac_f32_32x32x32_bf16 v[60:75], v[88:91], v[36:43], v3
  s_mov_b64 exec, s[32:33]
  ds_read_b128 v[84:87], v2 offset:25600
  ds_read_b128 v[88:91], v2 offset:25856
  s_mov_b64 exec, -1
  v_exp_f32 v46, v46
  v_exp_f32 v47, v47
  v_exp_f32 v48, v48
  v_exp_f32 v49, v49
  v_mfma_f32_32x32x16_bf16 v[28:43], v[76:79], v[8:11], v[12:27]
  ds_read_b128 v[80:83], v2 offset:26624
  v_exp_f32 v50, v50
  v_exp_f32 v51, v51
  v_exp_f32 v52, v52
  v_exp_f32 v53, v53
  v_exp_f32 v54, v54
  v_smfmac_f32_32x32x32_bf16 v[60:75], v[92:95], v[44:51], v3
  v_exp_f32 v55, v55
  v_exp_f32 v56, v56
  v_exp_f32 v57, v57
  v_exp_f32 v58, v58
  v_exp_f32 v59, v59
  s_cmp_gt_u32 s18, s100
  s_cbranch_scc0 skip65
  s_setprio 2
skip65:
  s_cmp_gt_u32 s43, s100
  s_cbranch_scc0 skip66
  s_lshl_b32 s3, s101, 2
  s_add_u32 s3, s3, s24
  s_sub_u32 s3, s3, 4
  s_lshl_b32 s14, s3, 10
  s_add_u32 s14, s14, 13959168
  s_lshl_b32 s16, s3, 13
  s_add_u32 s16, s16, 8388608
  v_and_b32 v5, 7, v0
  v_lshlrev_b32 v5, 7, v5
  buffer_load_dwordx2 v[104:105], v5, s[20:23], s14 offen sc1
skip66:
  buffer_load_dwordx4 v[160:163], v1, s[20:23], s19 offen offset:0 sc1
  s_waitcnt lgkmcnt(0)
  v_exp_f32 v28, v28
  v_exp_f32 v29, v29
  v_smfmac_f32_32x32x32_bf16 v[60:75], v[96:99], v[52:59], v3
  s_mov_b64 exec, s[32:33]
  ds_read_b128 v[92:95], v2 offset:27648
  ds_read_b128 v[96:99], v2 offset:27904
  s_mov_b64 exec, -1
  v_exp_f32 v30, v30
  v_exp_f32 v31, v31
  v_exp_f32 v32, v32
  v_exp_f32 v33, v33
  v_mfma_f32_32x32x16_bf16 v[44:59], v[80:83], v[8:11], v[12:27]
  ds_read_b128 v[76:79], v2 offset:28672
  v_exp_f32 v34, v34
  v_exp_f32 v35, v35
  v_exp_f32 v36, v36
  v_exp_f32 v37, v37
  v_exp_f32 v38, v38
  v_smfmac_f32_32x32x32_bf16 v[60:75], v[84:87], v[28:35], v3
  v_exp_f32 v39, v39
  v_exp_f32 v40, v40
  v_exp_f32 v41, v41
  v_exp_f32 v42, v42
  v_exp_f32 v43, v43
  s_add_u32 s19, s42, 4096
  buffer_load_dwordx4 v[156:159], v1, s[20:23], s19 offen offset:3072 sc1
  s_waitcnt lgkmcnt(0)
  v_exp_f32 v44, v44
  v_exp_f32 v45, v45
  v_smfmac_f32_32x32x32_bf16 v[60:75], v[88:91], v[36:43], v3
  s_mov_b64 exec, s[32:33]
  ds_read_b128 v[84:87], v2 offset:29696
  ds_read_b128 v[88:91], v2 offset:29952
  s_mov_b64 exec, -1
  v_exp_f32 v46, v46
  v_exp_f32 v47, v47
  v_exp_f32 v48, v48
  v_exp_f32 v49, v49
  v_mfma_f32_32x32x16_bf16 v[28:43], v[76:79], v[8:11], v[12:27]
  ds_read_b128 v[80:83], v2 offset:30720
  v_exp_f32 v50, v50
  v_exp_f32 v51, v51
  v_exp_f32 v52, v52
  v_exp_f32 v53, v53
  v_exp_f32 v54, v54
  v_smfmac_f32_32x32x32_bf16 v[60:75], v[92:95], v[44:51], v3
  v_exp_f32 v55, v55
  v_exp_f32 v56, v56
  v_exp_f32 v57, v57
  v_exp_f32 v58, v58
  v_exp_f32 v59, v59
  buffer_load_dwordx4 v[152:155], v1, s[20:23], s19 offen offset:2048 sc1
  s_waitcnt lgkmcnt(0)
  v_exp_f32 v28, v28
  v_exp_f32 v29, v29
  v_smfmac_f32_32x32x32_bf16 v[60:75], v[96:99], v[52:59], v3
  s_mov_b64 exec, s[32:33]
  ds_read_b128 v[92:95], v2 offset:31744
  ds_read_b128 v[96:99], v2 offset:32000
  s_mov_b64 exec, -1
  v_exp_f32 v30, v30
  v_exp_f32 v31, v31
  v_exp_f32 v32, v32
  v_exp_f32 v33, v33
  v_mfma_f32_32x32x16_bf16 v[44:59], v[80:83], v[8:11], v[12:27]
  ds_read_b128 v[76:79], v2 offset:32768
  v_exp_f32 v34, v34
  v_exp_f32 v35, v35
  v_exp_f32 v36, v36
  v_exp_f32 v37, v37
  v_exp_f32 v38, v38
  v_smfmac_f32_32x32x32_bf16 v[60:75], v[84:87], v[28:35], v3
  v_exp_f32 v39, v39
  v_exp_f32 v40, v40
  v_exp_f32 v41, v41
  v_exp_f32 v42, v42
  v_exp_f32 v43, v43
  buffer_load_dwordx4 v[148:151], v1, s[20:23], s19 offen offset:1024 sc1
  s_waitcnt lgkmcnt(0)
  v_exp_f32 v44, v44
  v_exp_f32 v45, v45
  v_smfmac_f32_32x32x32_bf16 v[60:75], v[88:91], v[36:43], v3
  s_mov_b64 exec, s[32:33]
  ds_read_b128 v[84:87], v2 offset:33792
  ds_read_b128 v[88:91], v2 offset:34048
  s_mov_b64 exec, -1
  v_exp_f32 v46, v46
  v_exp_f32 v47, v47
  v_exp_f32 v48, v48
  v_exp_f32 v49, v49
  v_mfma_f32_32x32x16_bf16 v[28:43], v[76:79], v[8:11], v[12:27]
  ds_read_b128 v[80:83], v2 offset:34816
  v_exp_f32 v50, v50
  v_exp_f32 v51, v51
  v_exp_f32 v52, v52
  v_exp_f32 v53, v53
  v_exp_f32 v54, v54
  v_smfmac_f32_32x32x32_bf16 v[60:75], v[92:95], v[44:51], v3
  v_exp_f32 v55, v55
  v_exp_f32 v56, v56
  v_exp_f32 v57, v57
  v_exp_f32 v58, v58
  v_exp_f32 v59, v59
  s_cmp_gt_u32 s43, s100
  s_cbranch_scc0 skip67
  s_waitcnt vmcnt(4)
  v_cmp_ne_u64 vcc, s[98:99], v[104:105]
  s_nop 3
  s_cbranch_vccz seen68
  v_and_b32 v5, 7, v0
  v_lshlrev_b32 v5, 7, v5
  s_mov_b32 s10, 0x200000
poll69:
  buffer_load_dwordx2 v[6:7], v5, s[20:23], s14 offen sc1
  s_waitcnt vmcnt(0)
  v_cmp_ne_u64 vcc, s[98:99], v[6:7]
  s_nop 3
  s_cbranch_vccz poll69_ok
  s_sub_u32 s10, s10, 1
  s_cbranch_scc0 poll69
poll69_ok:
seen68:
skip67:
  buffer_load_dwordx4 v[144:147], v1, s[20:23], s19 offen offset:0 sc1
  s_waitcnt lgkmcnt(0)
  v_exp_f32 v28, v28
  v_exp_f32 v29, v29
  v_smfmac_f32_32x32x32_bf16 v[60:75], v[96:99], v[52:59], v3
  s_mov_b64 exec, s[32:33]
  ds_read_b128 v[92:95], v2 offset:35840
  ds_read_b128 v[96:99], v2 offset:36096
  s_mov_b64 exec, -1
  v_exp_f32 v30, v30
  v_exp_f32 v31, v31
  v_exp_f32 v32, v32
  v_exp_f32 v33, v33
  v_mfma_f32_32x32x16_bf16 v[44:59], v[80:83], v[8:11], v[12:27]
  ds_read_b128 v[76:79], v2 offset:36864
  v_exp_f32 v34, v34
  v_exp_f32 v35, v35
  v_exp_f32 v36, v36
  v_exp_f32 v37, v37
  v_exp_f32 v38, v38
  v_smfmac_f32_32x32x32_bf16 v[60:75], v[84:87], v[28:35], v3
  v_exp_f32 v39, v39
  v_exp_f32 v40, v40
  v_exp_f32 v41, v41
  v_exp_f32 v42, v42
  v_exp_f32 v43, v43
  s_cmp_gt_u32 s18, s100
  s_cbranch_scc0 skip70
  s_setprio 0
skip70:
  s_add_u32 s19, s42, 0
  buffer_load_dwordx4 v[140:143], v1, s[20:23], s19 offen offset:3072 sc1
  s_waitcnt lgkmcnt(0)
  v_exp_f32 v44, v44
  v_exp_f32 v45, v45
  v_smfmac_f32_32x32x32_bf16 v[60:75], v[88:91], v[36:43], v3
  s_mov_b64 exec, s[32:33]
  ds_read_b128 v[84:87], v2 offset:37888
  ds_read_b128 v[88:91], v2 offset:38144
  s_mov_b64 exec, -1
  v_exp_f32 v46, v46
  v_exp_f32 v47, v47
  v_exp_f32 v48, v48
  v_exp_f32 v49, v49
  v_mfma_f32_32x32x16_bf16 v[28:43], v[76:79], v[8:11], v[12:27]
  ds_read_b128 v[80:83], v2 offset:38912
  v_exp_f32 v50, v50
  v_exp_f32 v51, v51
  v_exp_f32 v52, v52
  v_exp_f32 v53, v53
  v_exp_f32 v54, v54
  v_smfmac_f32_32x32x32_bf16 v[60:75], v[92:95], v[44:51], v3
  v_exp_f32 v55, v55
  v_exp_f32 v56, v56
  v_exp_f32 v57, v57
  v_exp_f32 v58, v58
  v_exp_f32 v59, v59
  buffer_load_dwordx4 v[136:139], v1, s[20:23], s19 offen offset:2048 sc1
  s_waitcnt lgkmcnt(0)
  v_exp_f32 v28, v28
  v_exp_f32 v29, v29
  v_smfmac_f32_32x32x32_bf16 v[60:75], v[96:99], v[52:59], v3
  s_mov_b64 exec, s[32:33]
  ds_read_b128 v[92:95], v2 offset:39936
  ds_read_b128 v[96:99], v2 offset:40192
  s_mov_b64 exec, -1
  v_exp_f32 v30, v30
  v_exp_f32 v31, v31
  v_exp_f32 v32, v32
  v_exp_f32 v33, v33
  v_mfma_f32_32x32x16_bf16 v[44:59], v[80:83], v[8:11], v[12:27]
  ds_read_b128 v[76:79], v2 offset:40960
  v_exp_f32 v34, v34
  v_exp_f32 v35, v35
  v_exp_f32 v36, v36
  v_exp_f32 v37, v37
  v_exp_f32 v38, v38
  v_smfmac_f32_32x32x32_bf16 v[60:75], v[84:87], v[28:35], v3
  v_exp_f32 v39, v39
  v_exp_f32 v40, v40
  v_exp_f32 v41, v41
  v_exp_f32 v42, v42
  v_exp_f32 v43, v43
  s_cmp_gt_u32 s18, s100
  s_cbranch_scc0 skip71
  s_setprio 2
skip71:
  buffer_load_dwordx4 v[132:135], v1, s[20:23], s19 offen offset:1024 sc1
  s_waitcnt lgkmcnt(0)
  v_exp_f32 v44, v44
  v_exp_f32 v45, v45
  v_smfmac_f32_32x32x32_bf16 v[60:75], v[88:91], v[36:43], v3
  s_mov_b64 exec, s[32:33]
  ds_read_b128 v[84:87], v2 offset:41984
  ds_read_b128 v[88:91], v2 offset:42240
  s_mov_b64 exec, -1
  v_exp_f32 v46, v46
  v_exp_f32 v47, v47
  v_exp_f32 v48, v48
  v_exp_f32 v49, v49
  v_mfma_f32_32x32x16_bf16 v[28:43], v[76:79], v[8:11], v[12:27]
  ds_read_b128 v[80:83], v2 offset:43008
  v_exp_f32 v50, v50
  v_exp_f32 v51, v51
  v_exp_f32 v52, v52
  v_exp_f32 v53, v53
  v_exp_f32 v54, v54
  v_smfmac_f32_32x32x32_bf16 v[60:75], v[92:95], v[44:51], v3
  v_exp_f32 v55, v55
  v_exp_f32 v56, v56
  v_exp_f32 v57, v57
  v_exp_f32 v58, v58
  v_exp_f32 v59, v59
  buffer_load_dwordx4 v[128:131], v1, s[20:23], s19 offen offset:0 sc1
  s_waitcnt lgkmcnt(0)
  v_exp_f32 v28, v28
  v_exp_f32 v29, v29
  v_smfmac_f32_32x32x32_bf16 v[60:75], v[96:99], v[52:59], v3
  s_mov_b64 exec, s[32:33]
  ds_read_b128 v[92:95], v2 offset:44032
  ds_read_b128 v[96:99], v2 offset:44288
  s_mov_b64 exec, -1
  v_exp_f32 v30, v30
  v_exp_f32 v31, v31
  v_exp_f32 v32, v32
  v_exp_f32 v33, v33
  v_mfma_f32_32x32x16_bf16 v[44:59], v[80:83], v[8:11], v[12:27]
  ds_read_b128 v[76:79], v2 offset:45056
  v_exp_f32 v34, v34
  v_exp_f32 v35, v35
  v_exp_f32 v36, v36
  v_exp_f32 v37, v37
  v_exp_f32 v38, v38
  v_smfmac_f32_32x32x32_bf16 v[60:75], v[84:87], v[28:35], v3
  v_exp_f32 v39, v39
  v_exp_f32 v40, v40
  v_exp_f32 v41, v41
  v_exp_f32 v42, v42
  v_exp_f32 v43, v43
  s_cmp_lg_u32 s100, 0
  s_cbranch_scc1 skip72
  s_lshl_b32 s3, s101, 7
  s_lshl_b32 s3, s3, 4
  s_add_u32 s40, s3, 13828096
  v_and_b32 v5, 15, v0
  v_lshlrev_b32 v5, 7, v5
  buffer_load_dwordx2 v[102:103], v5, s[20:23], s40 offen sc1
skip72:
  s_waitcnt lgkmcnt(0)
  v_exp_f32 v44, v44
  v_exp_f32 v45, v45
  v_smfmac_f32_32x32x32_bf16 v[60:75], v[88:91], v[36:43], v3
  s_mov_b64 exec, s[32:33]
  ds_read_b128 v[84:87], v2 offset:46080
  ds_read_b128 v[88:91], v2 offset:46336
  s_mov_b64 exec, -1
  v_exp_f32 v46, v46
  v_exp_f32 v47, v47
  v_exp_f32 v48, v48
  v_exp_f32 v49, v49
  v_mfma_f32_32x32x16_bf16 v[28:43], v[76:79], v[8:11], v[12:27]
  ds_read_b128 v[80:83], v2 offset:47104
  v_exp_f32 v50, v50
  v_exp_f32 v51, v51
  v_exp_f32 v52, v52
  v_exp_f32 v53, v53
  v_exp_f32 v54, v54
  v_smfmac_f32_32x32x32_bf16 v[60:75], v[92:95], v[44:51], v3
  v_exp_f32 v55, v55
  v_exp_f32 v56, v56
  v_exp_f32 v57, v57
  v_exp_f32 v58, v58
  v_exp_f32 v59, v59
  s_waitcnt lgkmcnt(0)
  v_exp_f32 v28, v28
  v_exp_f32 v29, v29
  v_smfmac_f32_32x32x32_bf16 v[60:75], v[96:99], v[52:59], v3
  s_mov_b64 exec, s[32:33]
  ds_read_b128 v[92:95], v2 offset:48128
  ds_read_b128 v[96:99], v2 offset:48384
  s_mov_b64 exec, -1
  v_exp_f32 v30, v30
  v_exp_f32 v31, v31
  v_exp_f32 v32, v32
  v_exp_f32 v33, v33
  v_mfma_f32_32x32x16_bf16 v[44:59], v[80:83], v[8:11], v[12:27]
  ds_read_b128 v[76:79], v2 offset:49152
  v_exp_f32 v34, v34
  v_exp_f32 v35, v35
  v_exp_f32 v36, v36
  v_exp_f32 v37, v37
  v_exp_f32 v38, v38
  v_smfmac_f32_32x32x32_bf16 v[60:75], v[84:87], v[28:35], v3
  v_exp_f32 v39, v39
  v_exp_f32 v40, v40
  v_exp_f32 v41, v41
  v_exp_f32 v42, v42
  v_exp_f32 v43, v43
  s_waitcnt lgkmcnt(0)
  v_exp_f32 v44, v44
  v_exp_f32 v45, v45
  v_smfmac_f32_32x32x32_bf16 v[60:75], v[88:91], v[36:43], v3
  s_mov_b64 exec, s[32:33]
  ds_read_b128 v[84:87], v2 offset:50176
  ds_read_b128 v[88:91], v2 offset:50432
  s_mov_b64 exec, -1
  v_exp_f32 v46, v46
  v_exp_f32 v47, v47
  v_exp_f32 v48, v48
  v_exp_f32 v49, v49
  v_mfma_f32_32x32x16_bf16 v[28:43], v[76:79], v[8:11], v[12:27]
  ds_read_b128 v[80:83], v2 offset:51200
  v_exp_f32 v50, v50
  v_exp_f32 v51, v51
  v_exp_f32 v52, v52
  v_exp_f32 v53, v53
  v_exp_f32 v54, v54
  v_smfmac_f32_32x32x32_bf16 v[60:75], v[92:95], v[44:51], v3
  v_exp_f32 v55, v55
  v_exp_f32 v56, v56
  v_exp_f32 v57, v57
  v_exp_f32 v58, v58
  v_exp_f32 v59, v59
  s_cmp_gt_u32 s18, s100
  s_cbranch_scc0 skip73
  s_setprio 0
skip73:
  s_cmp_lg_u32 s100, 0
  s_cbranch_scc1 skip74
  s_waitcnt vmcnt(0)
  v_cmp_ne_u64 vcc, s[98:99], v[102:103]
  s_nop 3
  s_cbranch_vccz seen75
  v_and_b32 v5, 15, v0
  v_lshlrev_b32 v5, 7, v5
  s_mov_b32 s10, 0x200000
poll76:
  buffer_load_dwordx2 v[6:7], v5, s[20:23], s40 offen sc1
  s_waitcnt vmcnt(0)
  v_cmp_ne_u64 vcc, s[98:99], v[6:7]
  s_nop 3
  s_cbranch_vccz poll76_ok
  s_sub_u32 s10, s10, 1
  s_cbranch_scc0 poll76
poll76_ok:
seen75:
  s_lshl_b32 s3, s101, 15
  s_lshl_b32 s30, s24, 12
  s_add_u32 s3, s3, s30
  s_add_u32 s3, s3, 6291456
  s_mov_b32 m0, s4
  s_nop 0
  buffer_load_dwordx4 v1, s[20:23], s3 offen offset:0 sc1 lds
  buffer_load_dwordx4 v1, s[20:23], s3 offen offset:1024 sc1 lds
  buffer_load_dwordx4 v1, s[20:23], s3 offen offset:2048 sc1 lds
  buffer_load_dwordx4 v1, s[20:23], s3 offen offset:3072 sc1 lds
skip74:
  s_waitcnt lgkmcnt(0)
  v_exp_f32 v28, v28
  v_exp_f32 v29, v29
  v_smfmac_f32_32x32x32_bf16 v[60:75], v[96:99], v[52:59], v3
  s_mov_b64 exec, s[32:33]
  ds_read_b128 v[92:95], v2 offset:52224
  ds_read_b128 v[96:99], v2 offset:52480
  s_mov_b64 exec, -1
  v_exp_f32 v30, v30
  v_exp_f32 v31, v31
  v_exp_f32 v32, v32
  v_exp_f32 v33, v33
  v_mfma_f32_32x32x16_bf16 v[44:59], v[80:83], v[8:11], v[12:27]
  ds_read_b128 v[76:79], v2 offset:53248
  v_exp_f32 v34, v34
  v_exp_f32 v35, v35
  v_exp_f32 v36, v36
  v_exp_f32 v37, v37
  v_exp_f32 v38, v38
  v_smfmac_f32_32x32x32_bf16 v[60:75], v[84:87], v[28:35], v3
  v_exp_f32 v39, v39
  v_exp_f32 v40, v40
  v_exp_f32 v41, v41
  v_exp_f32 v42, v42
  v_exp_f32 v43, v43
  s_waitcnt lgkmcnt(0)
  v_exp_f32 v44, v44
  v_exp_f32 v45, v45
  v_smfmac_f32_32x32x32_bf16 v[60:75], v[88:91], v[36:43], v3
  s_mov_b64 exec, s[32:33]
  ds_read_b128 v[84:87], v2 offset:54272
  ds_read_b128 v[88:91], v2 offset:54528
  s_mov_b64 exec, -1
  v_exp_f32 v46, v46
  v_exp_f32 v47, v47
  v_exp_f32 v48, v48
  v_exp_f32 v49, v49
  v_mfma_f32_32x32x16_bf16 v[28:43], v[76:79], v[8:11], v[12:27]
  ds_read_b128 v[80:83], v2 offset:55296
  v_exp_f32 v50, v50
  v_exp_f32 v51, v51
  v_exp_f32 v52, v52
  v_exp_f32 v53, v53
  v_exp_f32 v54, v54
  v_smfmac_f32_32x32x32_bf16 v[60:75], v[92:95], v[44:51], v3
  v_exp_f32 v55, v55
  v_exp_f32 v56, v56
  v_exp_f32 v57, v57
  v_exp_f32 v58, v58
  v_exp_f32 v59, v59
  s_cmp_gt_u32 s18, s100
  s_cbranch_scc0 skip77
  s_setprio 2
skip77:
  s_waitcnt lgkmcnt(0)
  v_exp_f32 v28, v28
  v_exp_f32 v29, v29
  v_smfmac_f32_32x32x32_bf16 v[60:75], v[96:99], v[52:59], v3
  s_mov_b64 exec, s[32:33]
  ds_read_b128 v[92:95], v2 offset:56320
  ds_read_b128 v[96:99], v2 offset:56576
  s_mov_b64 exec, -1
  v_exp_f32 v30, v30
  v_exp_f32 v31, v31
  v_exp_f32 v32, v32
  v_exp_f32 v33, v33
  v_mfma_f32_32x32x16_bf16 v[44:59], v[80:83], v[8:11], v[12:27]
  ds_read_b128 v[76:79], v2 offset:57344
  v_exp_f32 v34, v34
  v_exp_f32 v35, v35
  v_exp_f32 v36, v36
  v_exp_f32 v37, v37
  v_exp_f32 v38, v38
  v_smfmac_f32_32x32x32_bf16 v[60:75], v[84:87], v[28:35], v3
  v_exp_f32 v39, v39
  v_exp_f32 v40, v40
  v_exp_f32 v41, v41
  v_exp_f32 v42, v42
  v_exp_f32 v43, v43
  s_waitcnt lgkmcnt(0)
  v_exp_f32 v44, v44
  v_exp_f32 v45, v45
  v_smfmac_f32_32x32x32_bf16 v[60:75], v[88:91], v[36:43], v3
  s_mov_b64 exec, s[32:33]
  ds_read_b128 v[84:87], v2 offset:58368
  ds_read_b128 v[88:91], v2 offset:58624
  s_mov_b64 exec, -1
  v_exp_f32 v46, v46
  v_exp_f32 v47, v47
  v_exp_f32 v48, v48
  v_exp_f32 v49, v49
  v_mfma_f32_32x32x16_bf16 v[28:43], v[76:79], v[8:11], v[12:27]
  ds_read_b128 v[80:83], v2 offset:59392
  v_exp_f32 v50, v50
  v_exp_f32 v51, v51
  v_exp_f32 v52, v52
  v_exp_f32 v53, v53
  v_exp_f32 v54, v54
  v_smfmac_f32_32x32x32_bf16 v[60:75], v[92:95], v[44:51], v3
  v_exp_f32 v55, v55
  v_exp_f32 v56, v56
  v_exp_f32 v57, v57
  v_exp_f32 v58, v58
  v_exp_f32 v59, v59
  s_waitcnt lgkmcnt(0)
  v_exp_f32 v28, v28
  v_exp_f32 v29, v29
  v_smfmac_f32_32x32x32_bf16 v[60:75], v[96:99], v[52:59], v3
  s_mov_b64 exec, s[32:33]
  ds_read_b128 v[92:95], v2 offset:60416
  ds_read_b128 v[96:99], v2 offset:60672
  s_mov_b64 exec, -1
  v_exp_f32 v30, v30
  v_exp_f32 v31, v31
  v_exp_f32 v32, v32
  v_exp_f32 v33, v33
  v_mfma_f32_32x32x16_bf16 v[44:59], v[80:83], v[8:11], v[12:27]
  ds_read_b128 v[76:79], v2 offset:61440
  v_exp_f32 v34, v34
  v_exp_f32 v35, v35
  v_exp_f32 v36, v36
  v_exp_f32 v37, v37
  v_exp_f32 v38, v38
  v_smfmac_f32_32x32x32_bf16 v[60:75], v[84:87], v[28:35], v3
  v_exp_f32 v39, v39
  v_exp_f32 v40, v40
  v_exp_f32 v41, v41
  v_exp_f32 v42, v42
  v_exp_f32 v43, v43
  s_waitcnt lgkmcnt(0)
  v_exp_f32 v44, v44
  v_exp_f32 v45, v45
  v_smfmac_f32_32x32x32_bf16 v[60:75], v[88:91], v[36:43], v3
  s_mov_b64 exec, s[32:33]
  ds_read_b128 v[84:87], v2 offset:62464
  ds_read_b128 v[88:91], v2 offset:62720
  s_mov_b64 exec, -1
  v_exp_f32 v46, v46
  v_exp_f32 v47, v47
  v_exp_f32 v48, v48
  v_exp_f32 v49, v49
  v_mfma_f32_32x32x16_bf16 v[28:43], v[76:79], v[8:11], v[12:27]
  ds_read_b128 v[80:83], v2 offset:63488
  v_exp_f32 v50, v50
  v_exp_f32 v51, v51
  v_exp_f32 v52, v52
  v_exp_f32 v53, v53
  v_exp_f32 v54, v54
  v_smfmac_f32_32x32x32_bf16 v[60:75], v[92:95], v[44:51], v3
  v_exp_f32 v55, v55
  v_exp_f32 v56, v56
  v_exp_f32 v57, v57
  v_exp_f32 v58, v58
  v_exp_f32 v59, v59
  s_waitcnt lgkmcnt(0)
  v_exp_f32 v28, v28
  v_exp_f32 v29, v29
  v_smfmac_f32_32x32x32_bf16 v[60:75], v[96:99], v[52:59], v3
  s_mov_b64 exec, s[32:33]
  ds_read_b128 v[92:95], v2 offset:64512
  ds_read_b128 v[96:99], v2 offset:64768
  s_mov_b64 exec, -1
  v_exp_f32 v30, v30
  v_exp_f32 v31, v31
  v_exp_f32 v32, v32
  v_exp_f32 v33, v33
  v_mfma_f32_32x32x16_bf16 v[44:59], v[80:83], v[8:11], v[12:27]
  v_exp_f32 v34, v34
  v_exp_f32 v35, v35
  v_exp_f32 v36, v36
  v_exp_f32 v37, v37
  v_exp_f32 v38, v38
  v_smfmac_f32_32x32x32_bf16 v[60:75], v[84:87], v[28:35], v3
  v_exp_f32 v39, v39
  v_exp_f32 v40, v40
  v_exp_f32 v41, v41
  v_exp_f32 v42, v42
  v_exp_f32 v43, v43
  s_cmp_gt_u32 s18, s100
  s_cbranch_scc0 skip78
  s_setprio 0
skip78:
  s_waitcnt lgkmcnt(0)
  v_exp_f32 v44, v44
  v_exp_f32 v45, v45
  v_smfmac_f32_32x32x32_bf16 v[60:75], v[88:91], v[36:43], v3
  v_exp_f32 v46, v46
  v_exp_f32 v47, v47
  v_exp_f32 v48, v48
  v_exp_f32 v49, v49
  v_exp_f32 v50, v50
  v_exp_f32 v51, v51
  v_exp_f32 v52, v52
  v_exp_f32 v53, v53
  v_exp_f32 v54, v54
  v_smfmac_f32_32x32x32_bf16 v[60:75], v[92:95], v[44:51], v3
  v_exp_f32 v55, v55
  v_exp_f32 v56, v56
  v_exp_f32 v57, v57
  v_exp_f32 v58, v58
  v_exp_f32 v59, v59
  s_nop 1
  v_smfmac_f32_32x32x32_bf16 v[60:75], v[96:99], v[52:59], v3
  v_and_b32 v6, 31, v0
  v_lshlrev_b32 v6, 11, v6
  v_lshrrev_b32 v7, 5, v0
  v_lshl_add_u32 v104, v7, 5, v6
  s_lshl_b32 s6, s101, 16
  s_lshr_b32 s3, s24, 2
  s_lshl_b32 s3, s3, 10
  s_add_u32 s6, s6, s3
  s_add_u32 s6, s6, s5
  v_mov_b32 v102, 0x0a800000
  s_cmp_lg_u32 s100, 0
  s_cbranch_scc1 attn_final
  v_add_f32_e64 v100, abs(v60), abs(v61)
  v_add_f32_e64 v101, abs(v62), abs(v63)
  v_add_f32_e64 v100, v100, abs(v64)
  v_add_f32_e64 v101, v101, abs(v65)
  v_add_f32_e64 v100, v100, abs(v66)
  v_add_f32_e64 v101, v101, abs(v67)
  v_add_f32 v100, v100, v101
  v_cmp_gt_f32 s[34:35], v102, v100
  v_add_f32 v100, v100, v68
  v_cmp_nle_f32 vcc, v100, v4
  s_nop 1
  s_or_b64 vcc, vcc, s[34:35]
  s_nop 0
  s_cbranch_vccz attn_final
  s_mov_b32 s100, 1
  v_mov_b32 v2, v1
  v_mov_b32 v100, 0xff800000
  s_mov_b32 s3, 64
attn_maxloop:
  ds_read_b128 v[76:79], v2
  v_add_u32 v2, 2048, v2
  s_waitcnt lgkmcnt(0)
  v_mfma_f32_32x32x16_bf16 v[28:43], v[76:79], v[8:11], 0
  s_nop 11
  v_max3_f32 v100, v100, v28, v29
  v_max3_f32 v100, v100, v30, v31
  v_max3_f32 v100, v100, v32, v33
  v_max3_f32 v100, v100, v34, v35
  v_max3_f32 v100, v100, v36, v37
  v_max3_f32 v100, v100, v38, v39
  v_max3_f32 v100, v100, v40, v41
  v_max3_f32 v100, v100, v42, v43
  s_sub_u32 s3, s3, 1
  s_cmp_lg_u32 s3, 0
  s_cbranch_scc1 attn_maxloop
  v_mov_b32 v2, v1
  ds_read_b128 v[76:79], v2
  ds_read_b128 v[80:83], v2 offset:2048
  s_mov_b64 exec, s[32:33]
  ds_read_b128 v[84:87], v2 offset:1024
  ds_read_b128 v[88:91], v2 offset:1280
  s_mov_b64 exec, -1
  v_mov_b32 v60, 0
  v_mov_b32 v61, 0
  v_mov_b32 v62, 0
  v_mov_b32 v63, 0
  v_mov_b32 v64, 0
  v_mov_b32 v65, 0
  v_mov_b32 v66, 0
  v_mov_b32 v67, 0
  v_mov_b32 v68, 0
  v_mov_b32 v69, 0
  v_mov_b32 v70, 0
  v_mov_b32 v71, 0
  v_mov_b32 v72, 0
  v_mov_b32 v73, 0
  v_mov_b32 v74, 0
  v_mov_b32 v75, 0
  s_waitcnt lgkmcnt(0)
  s_branch attn_restart
attn_final:
  v_rcp_f32 v100, v68
  s_nop 0
  v_mul_f32 v60, v60, v100
  v_mul_f32 v61, v61, v100
  v_mul_f32 v62, v62, v100
  v_mul_f32 v63, v63, v100
  v_mul_f32 v64, v64, v100
  v_mul_f32 v65, v65, v100
  v_mul_f32 v66, v66, v100
  v_mul_f32 v67, v67, v100
  v_cvt_pk_bf16_f32 v8, v60, v61
  v_cvt_pk_bf16_f32 v9, v62, v63
  v_cvt_pk_bf16_f32 v10, v64, v65
  v_cvt_pk_bf16_f32 v11, v66, v67
  v_min_u32 v8, -2, v8
  v_min_u32 v9, -2, v9
  v_min_u32 v10, -2, v10
  v_min_u32 v11, -2, v11
  buffer_store_dwordx4 v[8:11], v1, s[20:23], s12 offen sc1
  s_waitcnt vmcnt(1)
  s_barrier
  v_add_u32 v2, 131072, v1
  s_cmp_ge_u32 s24, 4
  s_cbranch_scc0 out_gemm
  s_sub_u32 s30, s24, 4
  s_lshl_b32 s30, s30, 13
  v_add_u32 v2, s30, v1
  s_add_u32 s17, s16, 4096
  s_mov_b32 s10, 0x200000
  buffer_load_dwordx4 v[16:19], v1, s[20:23], s16 offen offset:1024 sc1
  buffer_load_dwordx4 v[24:27], v1, s[20:23], s16 offen offset:3072 sc1
  buffer_load_dwordx4 v[32:35], v1, s[20:23], s17 offen offset:1024 sc1
  buffer_load_dwordx4 v[40:43], v1, s[20:23], s17 offen offset:3072 sc1
og_c1:
  s_waitcnt vmcnt(3)
  v_max3_u32 v6, v16, v17, v18
  v_max_u32 v6, v6, v19
  v_cmp_eq_u32 vcc, -1, v6
  s_nop 3
  s_cbranch_vccnz og_r1
  ds_write_b128 v2, v[16:19] offset:1024
og_c3:
  s_waitcnt vmcnt(2)
  v_max3_u32 v6, v24, v25, v26
  v_max_u32 v6, v6, v27
  v_cmp_eq_u32 vcc, -1, v6
  s_nop 3
  s_cbranch_vccnz og_r3
  ds_write_b128 v2, v[24:27] offset:3072
og_c5:
  s_waitcnt vmcnt(1)
  v_max3_u32 v6, v32, v33, v34
  v_max_u32 v6, v6, v35
  v_cmp_eq_u32 vcc, -1, v6
  s_nop 3
  s_cbranch_vccnz og_r5
  ds_write_b128 v2, v[32:35] offset:5120
og_c7:
  s_waitcnt vmcnt(0)
  v_max3_u32 v6, v40, v41, v42
  v_max_u32 v6, v6, v43
  v_cmp_eq_u32 vcc, -1, v6
  s_nop 3
  s_cbranch_vccnz og_r7
  ds_write_b128 v2, v[40:43] offset:7168
  s_branch og_donea
og_r1:
  s_sub_u32 s10, s10, 1
  s_cbranch_scc1 og_donea
  s_waitcnt vmcnt(0)
  buffer_load_dwordx4 v[16:19], v1, s[20:23], s16 offen offset:1024 sc1
  buffer_load_dwordx4 v[24:27], v1, s[20:23], s16 offen offset:3072 sc1
  buffer_load_dwordx4 v[32:35], v1, s[20:23], s17 offen offset:1024 sc1
  buffer_load_dwordx4 v[40:43], v1, s[20:23], s17 offen offset:3072 sc1
  s_branch og_c1
og_r3:
  s_sub_u32 s10, s10, 1
  s_cbranch_scc1 og_donea
  s_waitcnt vmcnt(0)
  buffer_load_dwordx4 v[24:27], v1, s[20:23], s16 offen offset:3072 sc1
  buffer_load_dwordx4 v[32:35], v1, s[20:23], s17 offen offset:1024 sc1
  buffer_load_dwordx4 v[40:43], v1, s[20:23], s17 offen offset:3072 sc1
  s_branch og_c3
og_r5:
  s_sub_u32 s10, s10, 1
  s_cbranch_scc1 og_donea
  s_waitcnt vmcnt(0)
  buffer_load_dwordx4 v[32:35], v1, s[20:23], s17 offen offset:1024 sc1
  buffer_load_dwordx4 v[40:43], v1, s[20:23], s17 offen offset:3072 sc1
  s_branch og_c5
og_r7:
  s_sub_u32 s10, s10, 1
  s_cbranch_scc1 og_donea
  s_waitcnt vmcnt(0)
  buffer_load_dwordx4 v[40:43], v1, s[20:23], s17 offen offset:3072 sc1
  s_branch og_c7
og_donea:
  buffer_load_dwordx4 v[12:15], v1, s[20:23], s16 offen offset:0 sc1
  buffer_load_dwordx4 v[20:23], v1, s[20:23], s16 offen offset:2048 sc1
  buffer_load_dwordx4 v[28:31], v1, s[20:23], s17 offen offset:0 sc1
  buffer_load_dwordx4 v[36:39], v1, s[20:23], s17 offen offset:2048 sc1
  s_waitcnt lgkmcnt(0)
  s_barrier
  ds_read_b128 v[76:79], v1 offset:1024
  ds_read_b128 v[80:83], v1 offset:3072
  ds_read_b128 v[84:87], v1 offset:5120
  ds_read_b128 v[88:91], v1 offset:7168
  ds_read_b128 v[92:95], v1 offset:9216
  ds_read_b128 v[96:99], v1 offset:11264
  ds_read_b128 v[100:103], v1 offset:13312
  ds_read_b128 v[104:107], v1 offset:15360
  s_waitcnt lgkmcnt(7)
  v_mfma_f32_32x32x16_bf16 v[60:75], v[132:135], v[76:79], 0
  ds_read_b128 v[76:79], v1 offset:17408
  s_waitcnt lgkmcnt(7)
  v_mfma_f32_32x32x16_bf16 v[60:75], v[140:143], v[80:83], v[60:75]
  ds_read_b128 v[80:83], v1 offset:19456
  s_waitcnt lgkmcnt(7)
  v_mfma_f32_32x32x16_bf16 v[60:75], v[148:151], v[84:87], v[60:75]
  ds_read_b128 v[84:87], v1 offset:21504
  s_waitcnt lgkmcnt(7)
  v_mfma_f32_32x32x16_bf16 v[60:75], v[156:159], v[88:91], v[60:75]
  ds_read_b128 v[88:91], v1 offset:23552
  s_waitcnt lgkmcnt(7)
  v_mfma_f32_32x32x16_bf16 v[60:75], v[164:167], v[92:95], v[60:75]
  ds_read_b128 v[92:95], v1 offset:25600
  s_waitcnt lgkmcnt(7)
  v_mfma_f32_32x32x16_bf16 v[60:75], v[172:175], v[96:99], v[60:75]
  ds_read_b128 v[96:99], v1 offset:27648
  s_waitcnt lgkmcnt(7)
  v_mfma_f32_32x32x16_bf16 v[60:75], v[180:183], v[100:103], v[60:75]
  ds_read_b128 v[100:103], v1 offset:29696
  s_waitcnt lgkmcnt(7)
  v_mfma_f32_32x32x16_bf16 v[60:75], v[188:191], v[104:107], v[60:75]
  ds_read_b128 v[104:107], v1 offset:31744
  s_waitcnt lgkmcnt(7)
  v_mfma_f32_32x32x16_bf16 v[60:75], v[196:199], v[76:79], v[60:75]
  s_waitcnt lgkmcnt(6)
  v_mfma_f32_32x32x16_bf16 v[60:75], v[204:207], v[80:83], v[60:75]
  s_waitcnt lgkmcnt(5)
  v_mfma_f32_32x32x16_bf16 v[60:75], v[212:215], v[84:87], v[60:75]
  s_waitcnt lgkmcnt(4)
  v_mfma_f32_32x32x16_bf16 v[60:75], v[220:223], v[88:91], v[60:75]
  s_waitcnt lgkmcnt(3)
  v_mfma_f32_32x32x16_bf16 v[60:75], v[228:231], v[92:95], v[60:75]
  s_waitcnt lgkmcnt(2)
  v_mfma_f32_32x32x16_bf16 v[60:75], v[236:239], v[96:99], v[60:75]
  s_waitcnt lgkmcnt(1)
  v_mfma_f32_32x32x16_bf16 v[60:75], v[244:247], v[100:103], v[60:75]
  s_waitcnt lgkmcnt(0)
  v_mfma_f32_32x32x16_bf16 v[60:75], v[252:255], v[104:107], v[60:75]
og_c0:
  s_waitcnt vmcnt(3)
  v_max3_u32 v6, v12, v13, v14
  v_max_u32 v6, v6, v15
  v_cmp_eq_u32 vcc, -1, v6
  s_nop 3
  s_cbranch_vccnz og_r0
  ds_write_b128 v2, v[12:15] offset:0
og_c2:
  s_waitcnt vmcnt(2)
  v_max3_u32 v6, v20, v21, v22
  v_max_u32 v6, v6, v23
  v_cmp_eq_u32 vcc, -1, v6
  s_nop 3
  s_cbranch_vccnz og_r2
  ds_write_b128 v2, v[20:23] offset:2048
og_c4:
  s_waitcnt vmcnt(1)
  v_max3_u32 v6, v28, v29, v30
  v_max_u32 v6, v6, v31
  v_cmp_eq_u32 vcc, -1, v6
  s_nop 3
  s_cbranch_vccnz og_r4
  ds_write_b128 v2, v[28:31] offset:4096
og_c6:
  s_waitcnt vmcnt(0)
  v_max3_u32 v6, v36, v37, v38
  v_max_u32 v6, v6, v39
  v_cmp_eq_u32 vcc, -1, v6
  s_nop 3
  s_cbranch_vccnz og_r6
  ds_write_b128 v2, v[36:39] offset:6144
  s_branch og_doneb
og_r0:
  s_sub_u32 s10, s10, 1
  s_cbranch_scc1 og_doneb
  s_waitcnt vmcnt(0)
  buffer_load_dwordx4 v[12:15], v1, s[20:23], s16 offen offset:0 sc1
  buffer_load_dwordx4 v[20:23], v1, s[20:23], s16 offen offset:2048 sc1
  buffer_load_dwordx4 v[28:31], v1, s[20:23], s17 offen offset:0 sc1
  buffer_load_dwordx4 v[36:39], v1, s[20:23], s17 offen offset:2048 sc1
  s_branch og_c0
og_r2:
  s_sub_u32 s10, s10, 1
  s_cbranch_scc1 og_doneb
  s_waitcnt vmcnt(0)
  buffer_load_dwordx4 v[20:23], v1, s[20:23], s16 offen offset:2048 sc1
  buffer_load_dwordx4 v[28:31], v1, s[20:23], s17 offen offset:0 sc1
  buffer_load_dwordx4 v[36:39], v1, s[20:23], s17 offen offset:2048 sc1
  s_branch og_c2
og_r4:
  s_sub_u32 s10, s10, 1
  s_cbranch_scc1 og_doneb
  s_waitcnt vmcnt(0)
  buffer_load_dwordx4 v[28:31], v1, s[20:23], s17 offen offset:0 sc1
  buffer_load_dwordx4 v[36:39], v1, s[20:23], s17 offen offset:2048 sc1
  s_branch og_c4
og_r6:
  s_sub_u32 s10, s10, 1
  s_cbranch_scc1 og_doneb
  s_waitcnt vmcnt(0)
  buffer_load_dwordx4 v[36:39], v1, s[20:23], s17 offen offset:2048 sc1
  s_branch og_c6
og_doneb:
  s_waitcnt lgkmcnt(0)
  s_barrier
  ds_read_b128 v[76:79], v1 offset:0
  ds_read_b128 v[80:83], v1 offset:2048
  ds_read_b128 v[84:87], v1 offset:4096
  ds_read_b128 v[88:91], v1 offset:6144
  ds_read_b128 v[92:95], v1 offset:8192
  ds_read_b128 v[96:99], v1 offset:10240
  ds_read_b128 v[100:103], v1 offset:12288
  ds_read_b128 v[104:107], v1 offset:14336
  s_waitcnt lgkmcnt(7)
  v_mfma_f32_32x32x16_bf16 v[60:75], v[128:131], v[76:79], v[60:75]
  ds_read_b128 v[76:79], v1 offset:16384
  s_waitcnt lgkmcnt(7)
  v_mfma_f32_32x32x16_bf16 v[60:75], v[136:139], v[80:83], v[60:75]
  ds_read_b128 v[80:83], v1 offset:18432
  s_waitcnt lgkmcnt(7)
  v_mfma_f32_32x32x16_bf16 v[60:75], v[144:147], v[84:87], v[60:75]
  ds_read_b128 v[84:87], v1 offset:20480
  s_waitcnt lgkmcnt(7)
  v_mfma_f32_32x32x16_bf16 v[60:75], v[152:155], v[88:91], v[60:75]
  ds_read_b128 v[88:91], v1 offset:22528
  s_waitcnt lgkmcnt(7)
  v_mfma_f32_32x32x16_bf16 v[60:75], v[160:163], v[92:95], v[60:75]
  ds_read_b128 v[92:95], v1 offset:24576
  s_waitcnt lgkmcnt(7)
  v_mfma_f32_32x32x16_bf16 v[60:75], v[168:171], v[96:99], v[60:75]
  ds_read_b128 v[96:99], v1 offset:26624
  s_waitcnt lgkmcnt(7)
  v_mfma_f32_32x32x16_bf16 v[60:75], v[176:179], v[100:103], v[60:75]
  ds_read_b128 v[100:103], v1 offset:28672
  s_waitcnt lgkmcnt(7)
  v_mfma_f32_32x32x16_bf16 v[60:75], v[184:187], v[104:107], v[60:75]
  ds_read_b128 v[104:107], v1 offset:30720
  s_waitcnt lgkmcnt(7)
  v_mfma_f32_32x32x16_bf16 v[60:75], v[192:195], v[76:79], v[60:75]
  s_waitcnt lgkmcnt(6)
  v_mfma_f32_32x32x16_bf16 v[60:75], v[200:203], v[80:83], v[60:75]
  s_waitcnt lgkmcnt(5)
  v_mfma_f32_32x32x16_bf16 v[60:75], v[208:211], v[84:87], v[60:75]
  s_waitcnt lgkmcnt(4)
  v_mfma_f32_32x32x16_bf16 v[60:75], v[216:219], v[88:91], v[60:75]
  s_waitcnt lgkmcnt(3)
  v_mfma_f32_32x32x16_bf16 v[60:75], v[224:227], v[92:95], v[60:75]
  s_waitcnt lgkmcnt(2)
  v_mfma_f32_32x32x16_bf16 v[60:75], v[232:235], v[96:99], v[60:75]
  s_waitcnt lgkmcnt(1)
  v_mfma_f32_32x32x16_bf16 v[60:75], v[240:243], v[100:103], v[60:75]
  s_waitcnt lgkmcnt(0)
  v_mfma_f32_32x32x16_bf16 v[60:75], v[248:251], v[104:107], v[60:75]
  s_branch out_done
out_gemm:
  ds_read_b128 v[12:15], v2 offset:0
  ds_read_b128 v[16:19], v2 offset:1024
  ds_read_b128 v[20:23], v2 offset:2048
  ds_read_b128 v[24:27], v2 offset:3072
  ds_read_b128 v[28:31], v2 offset:4096
  ds_read_b128 v[32:35], v2 offset:5120
  ds_read_b128 v[36:39], v2 offset:6144
  ds_read_b128 v[40:43], v2 offset:7168
  s_waitcnt lgkmcnt(7)
  v_mfma_f32_32x32x16_bf16 v[60:75], v[128:131], v[12:15], 0
  ds_read_b128 v[12:15], v2 offset:8192
  s_waitcnt lgkmcnt(7)
  v_mfma_f32_32x32x16_bf16 v[60:75], v[132:135], v[16:19], v[60:75]
  ds_read_b128 v[16:19], v2 offset:9216
  s_waitcnt lgkmcnt(7)
  v_mfma_f32_32x32x16_bf16 v[60:75], v[136:139], v[20:23], v[60:75]
  ds_read_b128 v[20:23], v2 offset:10240
  s_waitcnt lgkmcnt(7)
  v_mfma_f32_32x32x16_bf16 v[60:75], v[140:143], v[24:27], v[60:75]
  ds_read_b128 v[24:27], v2 offset:11264
  s_waitcnt lgkmcnt(7)
  v_mfma_f32_32x32x16_bf16 v[60:75], v[144:147], v[28:31], v[60:75]
  ds_read_b128 v[28:31], v2 offset:12288
  s_waitcnt lgkmcnt(7)
  v_mfma_f32_32x32x16_bf16 v[60:75], v[148:151], v[32:35], v[60:75]
  ds_read_b128 v[32:35], v2 offset:13312
  s_waitcnt lgkmcnt(7)
  v_mfma_f32_32x32x16_bf16 v[60:75], v[152:155], v[36:39], v[60:75]
  ds_read_b128 v[36:39], v2 offset:14336
  s_waitcnt lgkmcnt(7)
  v_mfma_f32_32x32x16_bf16 v[60:75], v[156:159], v[40:43], v[60:75]
  ds_read_b128 v[40:43], v2 offset:15360
  s_waitcnt lgkmcnt(7)
  v_mfma_f32_32x32x16_bf16 v[60:75], v[160:163], v[12:15], v[60:75]
  ds_read_b128 v[12:15], v2 offset:16384
  s_waitcnt lgkmcnt(7)
  v_mfma_f32_32x32x16_bf16 v[60:75], v[164:167], v[16:19], v[60:75]
  ds_read_b128 v[16:19], v2 offset:17408
  s_waitcnt lgkmcnt(7)
  v_mfma_f32_32x32x16_bf16 v[60:75], v[168:171], v[20:23], v[60:75]
  ds_read_b128 v[20:23], v2 offset:18432
  s_waitcnt lgkmcnt(7)
  v_mfma_f32_32x32x16_bf16 v[60:75], v[172:175], v[24:27], v[60:75]
  ds_read_b128 v[24:27], v2 offset:19456
  s_waitcnt lgkmcnt(7)
  v_mfma_f32_32x32x16_bf16 v[60:75], v[176:179], v[28:31], v[60:75]
  ds_read_b128 v[28:31], v2 offset:20480
  s_waitcnt lgkmcnt(7)
  v_mfma_f32_32x32x16_bf16 v[60:75], v[180:183], v[32:35], v[60:75]
  ds_read_b128 v[32:35], v2 offset:21504
  s_waitcnt lgkmcnt(7)
  v_mfma_f32_32x32x16_bf16 v[60:75], v[184:187], v[36:39], v[60:75]
  ds_read_b128 v[36:39], v2 offset:22528
  s_waitcnt lgkmcnt(7)
  v_mfma_f32_32x32x16_bf16 v[60:75], v[188:191], v[40:43], v[60:75]
  ds_read_b128 v[40:43], v2 offset:23552
  s_waitcnt lgkmcnt(7)
  v_mfma_f32_32x32x16_bf16 v[60:75], v[192:195], v[12:15], v[60:75]
  ds_read_b128 v[12:15], v2 offset:24576
  s_waitcnt lgkmcnt(7)
  v_mfma_f32_32x32x16_bf16 v[60:75], v[196:199], v[16:19], v[60:75]
  ds_read_b128 v[16:19], v2 offset:25600
  s_waitcnt lgkmcnt(7)
  v_mfma_f32_32x32x16_bf16 v[60:75], v[200:203], v[20:23], v[60:75]
  ds_read_b128 v[20:23], v2 offset:26624
  s_waitcnt lgkmcnt(7)
  v_mfma_f32_32x32x16_bf16 v[60:75], v[204:207], v[24:27], v[60:75]
  ds_read_b128 v[24:27], v2 offset:27648
  s_waitcnt lgkmcnt(7)
  v_mfma_f32_32x32x16_bf16 v[60:75], v[208:211], v[28:31], v[60:75]
  ds_read_b128 v[28:31], v2 offset:28672
  s_waitcnt lgkmcnt(7)
  v_mfma_f32_32x32x16_bf16 v[60:75], v[212:215], v[32:35], v[60:75]
  ds_read_b128 v[32:35], v2 offset:29696
  s_waitcnt lgkmcnt(7)
  v_mfma_f32_32x32x16_bf16 v[60:75], v[216:219], v[36:39], v[60:75]
  ds_read_b128 v[36:39], v2 offset:30720
  s_waitcnt lgkmcnt(7)
  v_mfma_f32_32x32x16_bf16 v[60:75], v[220:223], v[40:43], v[60:75]
  ds_read_b128 v[40:43], v2 offset:31744
  s_waitcnt lgkmcnt(7)
  v_mfma_f32_32x32x16_bf16 v[60:75], v[224:227], v[12:15], v[60:75]
  s_waitcnt lgkmcnt(6)
  v_mfma_f32_32x32x16_bf16 v[60:75], v[228:231], v[16:19], v[60:75]
  s_waitcnt lgkmcnt(5)
  v_mfma_f32_32x32x16_bf16 v[60:75], v[232:235], v[20:23], v[60:75]
  s_waitcnt lgkmcnt(4)
  v_mfma_f32_32x32x16_bf16 v[60:75], v[236:239], v[24:27], v[60:75]
  s_waitcnt lgkmcnt(3)
  v_mfma_f32_32x32x16_bf16 v[60:75], v[240:243], v[28:31], v[60:75]
  s_waitcnt lgkmcnt(2)
  v_mfma_f32_32x32x16_bf16 v[60:75], v[244:247], v[32:35], v[60:75]
  s_waitcnt lgkmcnt(1)
  v_mfma_f32_32x32x16_bf16 v[60:75], v[248:251], v[36:39], v[60:75]
  s_waitcnt lgkmcnt(0)
  v_mfma_f32_32x32x16_bf16 v[60:75], v[252:255], v[40:43], v[60:75]
  s_barrier
out_done:
  s_nop 11
  v_cvt_pk_bf16_f32 v12, v60, v61
  v_cvt_pk_bf16_f32 v13, v62, v63
  v_cvt_pk_bf16_f32 v14, v64, v65
  v_cvt_pk_bf16_f32 v15, v66, v67
  v_cvt_pk_bf16_f32 v16, v68, v69
  v_cvt_pk_bf16_f32 v17, v70, v71
  v_cvt_pk_bf16_f32 v18, v72, v73
  v_cvt_pk_bf16_f32 v19, v74, v75
  s_lshl_b32 s3, s24, 11
  s_add_u32 s3, s3, 98304
  v_and_b32 v6, 31, v0
  v_lshlrev_b32 v6, 6, v6
  v_lshrrev_b32 v7, 5, v0
  v_lshl_add_u32 v6, v7, 5, v6
  v_add_u32 v6, s3, v6
  v_add_u32 v7, s3, v1
  ds_write_b128 v6, v[12:15]
  ds_write_b128 v6, v[16:19] offset:16
  v_lshrrev_b32 v6, 2, v0
  v_lshlrev_b32 v6, 11, v6
  v_and_b32 v104, 3, v0
  v_lshl_add_u32 v104, v104, 4, v6
  s_add_u32 s7, s6, 32768
  s_waitcnt lgkmcnt(0)
  ds_read_b128 v[20:23], v7
  ds_read_b128 v[24:27], v7 offset:1024
  s_waitcnt lgkmcnt(1)
  buffer_store_dwordx4 v[20:23], v104, s[56:59], s6 offen sc1
  s_waitcnt lgkmcnt(0)
  buffer_store_dwordx4 v[24:27], v104, s[56:59], s7 offen sc1
  s_cmp_ge_u32 s24, 4
  s_cbranch_scc1 no_e2
  s_barrier
no_e2:
k_end:
  s_endpgm
.section .rodata,"a"
.p2align 6
.amdhsa_kernel concat_heads__linear_kernel_hedgehog__softmax_full_mha__prompt_kernel
  .amdhsa_next_free_vgpr 256
  .amdhsa_next_free_sgpr 102
  .amdhsa_accum_offset 256
  .amdhsa_group_segment_fixed_size 0
  .amdhsa_kernarg_size 80
  .amdhsa_user_sgpr_count 2
  .amdhsa_user_sgpr_kernarg_segment_ptr 1
  .amdhsa_system_sgpr_workgroup_id_x 1
.end_amdhsa_kernel
```
